```python
import torch

def _softmax(x, axis=-1):
    return torch.softmax(x, dim=axis)
def _gelu(x):
    return torch.nn.functional.gelu(x, approximate="tanh")
def _silu(x):
    return torch.nn.functional.silu(x)
def _sigmoid(x):
    return torch.sigmoid(x)
def _layernorm(x, axis=-1, eps=1e-5):
    m = x.mean(dim=axis, keepdim=True)
    v = x.var(dim=axis, keepdim=True, unbiased=False)
    return (x - m) / torch.sqrt(v + eps)
def _scatter_add(tgt, idx, src, axis=0):
    return tgt.clone().index_add_(axis, idx, src)
def _segment_sum(src, seg, n):
    out = torch.zeros((n,) + src.shape[1:], dtype=src.dtype)
    return out.index_add_(0, seg, src)
def _pad(x, pw):
    flat = tuple(v for pair in reversed(pw) for v in pair)
    return torch.nn.functional.pad(x, flat)

kernel_name = 'recurrent_scan__gqa_block_cached__geglu_ffn__decode'

def setup_inputs():

    _w = (lambda a: (lambda t: t.to(torch.bfloat16) if t.is_floating_point() else t)(torch.as_tensor(a)))
    def _A_setup():
        B, Sq, D = 1, 1, 512
        Hq, Hkv, Sk, Dh = 32, 8, 65536, 128
        assert Hq % Hkv == 0, (Hq, Hkv)
        return {
            "x": _w((lambda *s: torch.randn(*s, dtype=torch.bfloat16) * 0.05)(B, Sq, D)),
            "k_cache": _w((lambda *s: torch.randn(*s, dtype=torch.bfloat16) * 1.6)(B, Hkv, Sk, Dh)),
            "v_cache": _w((lambda *s: torch.randn(*s, dtype=torch.bfloat16) * 0.8)(B, Hkv, Sk, Dh)),
            "wq": _w((lambda *s: torch.randn(*s, dtype=torch.bfloat16) * 1.6)(D, Hq * Dh) * (D ** -0.5)),
            "wo": _w((lambda *s: torch.randn(*s, dtype=torch.bfloat16) * 0.8)(Hq * Dh, D) * ((Hq * Dh) ** -0.5)),
        }
    _A_in = _A_setup()

    def _B_setup():
        B, S, D, F = 1, 1, 512, 1792
        return {
            "x": _w((lambda *s: torch.randn(*s, dtype=torch.bfloat16) * 0.05)(B, S, D)),
            "w_gate": _w((lambda *s: torch.randn(*s, dtype=torch.bfloat16) * 0.2)(D, F)),
            "w_up": _w((lambda *s: torch.randn(*s, dtype=torch.bfloat16) * 0.2)(D, F)),
            "w_down": _w((lambda *s: torch.randn(*s, dtype=torch.bfloat16) * 0.2)(F, D)),
        }
    _B_in = _B_setup()

    return {
        "A_x": _A_in["x"],
        "A_k_cache": _A_in["k_cache"],
        "A_v_cache": _A_in["v_cache"],
        "A_wq": _A_in["wq"],
        "A_wo": _A_in["wo"],
        "B_x": _B_in["x"],
        "B_w_gate": _B_in["w_gate"],
        "B_w_up": _B_in["w_up"],
        "B_w_down": _B_in["w_down"],
    }

def reference(A_x, A_k_cache, A_v_cache, A_wq, A_wo, B_x, B_w_gate, B_w_up, B_w_down):
    def _A_ref(x, k_cache, v_cache, wq, wo):
        B, Sq, D = x.shape
        Hq, Dh = 32, 128
        Hkv = k_cache.shape[1]
        rep = Hq // Hkv
        q = (lambda x, *d: x.permute(*d))((x @ wq).reshape(B, Sq, Hq, Dh), 0, 2, 1, 3)
        k = (lambda x, n, axis: torch.repeat_interleave(x, n, dim=axis))(k_cache, rep, axis=1)
        v = (lambda x, n, axis: torch.repeat_interleave(x, n, dim=axis))(v_cache, rep, axis=1)
        scores = torch.einsum("bhqd,bhkd->bhqk", q, k) * (Dh ** -0.5)
        p = _softmax(scores, axis=-1)
        o = torch.einsum("bhqk,bhkd->bhqd", p, v)
        return (lambda x, *d: x.permute(*d))(o, 0, 2, 1, 3).reshape(B, Sq, Hq * Dh) @ wo

    def _B_ref(x, w_gate, w_up, w_down):
        return (_gelu(x @ w_gate) * (x @ w_up)) @ w_down

    x = A_x
    xn = _layernorm(x, axis=-1)
    s = _A_ref(xn, A_k_cache, A_v_cache, A_wq, A_wo)
    g = _silu(_B_ref(xn, B_w_gate, B_w_up, B_w_down))
    return x + s * g
```

```asm
; @launch grid=(256,1,1) block=(320,1,1) lds=163840
.amdgcn_target "amdgcn-amd-amdhsa--gfx950"
.text
.globl recurrent_scan__gqa_block_cached__geglu_ffn__decode_kernel
.p2align 8
.type recurrent_scan__gqa_block_cached__geglu_ffn__decode_kernel,@function
recurrent_scan__gqa_block_cached__geglu_ffn__decode_kernel:
    s_cmp_ge_u32 s2, 256
    s_cbranch_scc1 L_end
    s_load_dwordx16 s[32:47], s[0:1], 0
    s_load_dwordx8 s[48:55], s[0:1], 64
    v_lshrrev_b32 v1, 6, v0
    v_and_b32 v0, 63, v0
    v_readfirstlane_b32 s24, v1
    s_lshr_b32 s25, s2, 5
    s_and_b32 s26, s2, 31
    v_lshrrev_b32 v1, 4, v0
    v_and_b32 v2, 15, v0
    s_and_b32 s3, s26, 7
    s_lshl_b32 s28, s25, 3
    s_add_u32 s28, s28, s3
    s_lshl_b32 s93, s25, 1
    s_add_u32 s93, s93, s26
    s_cmp_ge_u32 s26, 2
    s_cselect_b32 s93, 64, s93
    s_cmp_eq_u32 s24, 4
    s_cbranch_scc1 L_aux
    v_xor_b32 v3, v1, v2
    v_lshlrev_b32 v3, 4, v3
    v_lshl_or_b32 v4, v1, 8, v3
    v_xor_b32 v5, 64, v4
    v_xor_b32 v6, 128, v4
    v_xor_b32 v7, 192, v4
    v_lshlrev_b32 v3, 1, v1
    v_xor_b32 v3, v3, v2
    v_lshlrev_b32 v3, 4, v3
    v_lshl_or_b32 v8, v1, 8, v3
    v_xor_b32 v9, 0x80, v8
    s_add_u32 s91, s24, s26
    s_and_b32 s91, s91, 3
    s_lshl_b32 s27, s91, 12
    s_mul_i32 s3, s25, 1572864
    s_add_u32 s27, s27, s3
    s_lshl_b32 s5, s26, 14
    s_add_u32 s5, s5, s27
    s_and_b32 s91, s91, 3
    s_lshl_b32 s27, s91, 12
    s_add_u32 s27, s27, s3
    s_add_u32 s27, s27, 15728640
    s_lshl_b32 s29, s24, 15
    s_lshl_b32 s3, s25, 24
    s_waitcnt lgkmcnt(0)
    s_add_u32 s8, s34, s3
    s_addc_u32 s9, s35, 0
    s_mov_b32 s10, 0x1000000
    s_mov_b32 s11, 0x20000
    s_add_u32 s12, s36, s3
    s_addc_u32 s13, s37, 0
    s_mov_b32 s14, 0x1000000
    s_mov_b32 s15, 0x20000
    s_mov_b32 s20, s54
    s_mov_b32 s21, s55
    s_mov_b32 s22, 0x400000
    s_mov_b32 s23, 0x20000
    s_mov_b32 s92, s5
    s_and_b32 s4, s5, 0xffffff
    s_add_u32 m0, s29, 0
    s_add_u32 s5, s5, 0x80000
    buffer_load_dwordx4 v4, s[8:11], s4 offen offset:0 nt lds
    buffer_load_dwordx4 v5, s[8:11], s4 offen offset:1024 nt lds
    buffer_load_dwordx4 v6, s[8:11], s4 offen offset:2048 nt lds
    buffer_load_dwordx4 v7, s[8:11], s4 offen offset:3072 nt lds
    v_xor_b32 v3, v1, v2
    v_lshlrev_b32 v3, 4, v3
    v_lshl_or_b32 v3, v2, 8, v3
    v_add_u32 v10, s29, v3
    v_xor_b32 v11, 64, v10
    v_xor_b32 v12, 128, v10
    v_xor_b32 v13, 192, v10
    v_lshrrev_b32 v3, 2, v0
    v_and_b32 v82, 7, v3
    v_lshlrev_b32 v82, 5, v82
    v_lshl_or_b32 v3, v3, 8, v82
    v_and_b32 v82, 3, v0
    v_lshl_or_b32 v3, v82, 3, v3
    v_add_u32 v14, s29, v3
    v_xor_b32 v15, 32, v14
    v_xor_b32 v16, 64, v14
    v_xor_b32 v17, 96, v14
    v_xor_b32 v18, 128, v14
    v_xor_b32 v19, 160, v14
    v_xor_b32 v20, 192, v14
    v_xor_b32 v21, 224, v14
    s_barrier
    s_and_b32 s4, s5, 0xffffff
    s_add_u32 m0, s29, 16384
    s_add_u32 s5, s5, 0x80000
    buffer_load_dwordx4 v4, s[8:11], s4 offen offset:0 nt lds
    v_mov_b32 v88, 0
    v_mov_b32 v89, 0
    v_mov_b32 v90, 0
    v_mov_b32 v91, 0
    v_mov_b32 v92, 0
    v_mov_b32 v93, 0
    v_mov_b32 v94, 0
    v_mov_b32 v95, 0
    v_mov_b32 v96, 0
    v_mov_b32 v97, 0
    v_mov_b32 v98, 0
    v_mov_b32 v99, 0
    v_mov_b32 v100, 0
    v_mov_b32 v101, 0
    v_mov_b32 v102, 0
    v_mov_b32 v103, 0
    v_mov_b32 v104, 0
    v_mov_b32 v105, 0
    v_mov_b32 v106, 0
    v_mov_b32 v107, 0
    v_mov_b32 v108, 0
    v_mov_b32 v109, 0
    v_mov_b32 v110, 0
    v_mov_b32 v111, 0
    v_mov_b32 v112, 0
    v_mov_b32 v113, 0
    v_mov_b32 v114, 0
    v_mov_b32 v115, 0
    v_mov_b32 v116, 0
    v_mov_b32 v117, 0
    v_mov_b32 v118, 0
    v_mov_b32 v119, 0
    v_mov_b32 v78, 0xff7fffff
    v_mov_b32 v79, 0
    v_and_b32 v3, 3, v0
    s_lshl_b32 s3, s24, 12
    s_add_u32 s3, s3, 131072
    v_lshl_add_u32 v184, v0, 4, s3
    s_lshl_b32 s3, s24, 5
    s_add_u32 s3, s3, 149504
    v_lshl_add_u32 v185, v2, 1, s3
    v_lshl_add_u32 v187, v1, 3, s3
    s_mul_i32 s3, s25, 66560
    s_lshl_b32 s7, s26, 8
    s_add_u32 s3, s3, s7
    s_add_u32 s3, s3, 1048576
    v_mul_u32_u24 v188, 16640, v1
    v_lshl_add_u32 v188, v2, 4, v188
    v_add_u32 v188, s3, v188
    s_mul_i32 s3, s28, 8320
    s_lshl_b32 s7, s24, 6
    s_add_u32 s3, s3, s7
    s_add_u32 s3, s3, 1048576
    v_lshrrev_b32 v192, 2, v0
    v_lshlrev_b32 v189, 9, v192
    v_lshl_or_b32 v189, v3, 4, v189
    v_add_u32 v189, s3, v189
    s_lshl_b32 s3, s24, 3
    s_add_u32 s3, s3, 150272
    v_lshl_add_u32 v190, v3, 1, s3
    v_lshl_add_u32 v190, v1, 5, v190
    v_lshlrev_b32 v191, 4, v1
    v_add_u32 v191, 150272, v191
    v_lshrrev_b32 v198, 2, v2
    v_lshl_add_u32 v197, v1, 3, v198
    v_lshlrev_b32 v197, 7, v197
    v_lshl_or_b32 v197, v3, 3, v197
    v_lshrrev_b32 v198, 1, v198
    v_and_b32 v199, 1, v1
    v_lshl_or_b32 v198, v199, 1, v198
    v_lshl_or_b32 v197, v198, 5, v197
    s_lshr_b32 s3, s24, 1
    s_and_b32 s7, s24, 1
    s_lshl_b32 s3, s3, 15
    s_lshl_b32 s7, s7, 13
    s_add_u32 s3, s3, s7
    s_add_u32 s3, s3, 81920
    v_add_u32 v197, s3, v197
    v_xor_b32 v198, 32, v197
    v_xor_b32 v199, 64, v197
    v_xor_b32 v200, 96, v197
    s_lshr_b32 s3, s26, 3
    s_lshl_b32 s3, s3, 2
    s_add_u32 s3, s3, s24
    s_mul_i32 s3, s3, 16640
    s_lshl_b32 s7, s28, 7
    s_add_u32 s3, s3, s7
    s_add_u32 s3, s3, 2097152
    v_lshrrev_b32 v192, 5, v0
    v_mul_u32_u24 v192, 8320, v192
    v_and_b32 v193, 31, v0
    v_lshl_add_u32 v192, v193, 2, v192
    v_add_u32 v192, s3, v192
    s_mul_i32 s3, s93, 8320
    s_add_u32 s3, s3, 2097152
    v_lshl_add_u32 v193, v0, 4, s3
    v_and_b32 v194, 7, v0
    v_lshrrev_b32 v195, 5, v0
    v_lshl_or_b32 v194, v194, 1, v195
    v_and_b32 v195, 1, v1
    v_lshl_or_b32 v194, v194, 1, v195
    s_lshl_b32 s3, s93, 6
    v_lshl_add_u32 v195, v194, 1, s3
    v_lshlrev_b32 v194, 2, v194
    v_add_u32 v194, 149888, v194
    s_mov_b32 s6, 0x3fb8aa3b
    s_mul_i32 s3, s25, 4
    s_add_u32 s3, s3, s91
    s_mul_i32 s3, s3, 4096
    s_add_u32 s3, s3, 32768
    v_mov_b32 v3, s3
    v_mov_b32 v85, 0x7ffffff0
    v_cmp_eq_u32 vcc, 0, v0
    s_and_b32 s3, s28, 63
    s_lshl_b32 s7, s3, 16
    v_cndmask_b32 v85, v85, v3, vcc
    v_lshlrev_b32 v3, 2, v1
    v_xor_b32 v3, v3, v2
    v_lshlrev_b32 v3, 4, v3
    v_lshl_or_b32 v3, v1, 10, v3
    s_lshl_b32 s3, s24, 8
    v_add_u32 v196, s3, v3
    s_add_u32 s44, s40, s7
    s_addc_u32 s45, s41, 0
    s_mov_b32 s46, 0x10000
    s_mov_b32 s47, 0x20000
    s_mov_b32 s16, s50
    s_mov_b32 s17, s51
    s_mov_b32 s18, 0x400
    s_mov_b32 s19, 0x20000
    v_bfe_u32 v3, v0, 2, 2
    v_lshlrev_b32 v3, 5, v3
    v_lshl_or_b32 v3, v1, 3, v3
    s_lshl_b32 s3, s24, 12
    s_add_u32 s3, s3, 131072
    v_add_u32 v86, s3, v3
    s_waitcnt vmcnt(4)
    buffer_load_dwordx4 v5, s[8:11], s4 offen offset:1024 nt lds
    s_waitcnt vmcnt(4)
    buffer_load_dwordx4 v6, s[8:11], s4 offen offset:2048 nt lds
    s_waitcnt vmcnt(4)
    buffer_load_dwordx4 v7, s[8:11], s4 offen offset:3072 nt lds
    s_and_b32 s4, s5, 0xffffff
    s_add_u32 m0, s29, 4096
    s_add_u32 s5, s5, 0x80000
    s_waitcnt vmcnt(4)
    buffer_load_dwordx4 v4, s[8:11], s4 offen offset:0 nt lds
    s_waitcnt vmcnt(4)
    buffer_load_dwordx4 v5, s[8:11], s4 offen offset:1024 nt lds
    s_waitcnt vmcnt(4)
    buffer_load_dwordx4 v6, s[8:11], s4 offen offset:2048 nt lds
    s_waitcnt vmcnt(4)
    buffer_load_dwordx4 v7, s[8:11], s4 offen offset:3072 nt lds
    s_and_b32 s4, s5, 0xffffff
    s_add_u32 m0, s29, 20480
    s_add_u32 s5, s5, 0x80000
    s_waitcnt vmcnt(4)
    buffer_load_dwordx4 v4, s[8:11], s4 offen offset:0 nt lds
    s_waitcnt vmcnt(4)
    buffer_load_dwordx4 v5, s[8:11], s4 offen offset:1024 nt lds
    s_waitcnt vmcnt(4)
    buffer_load_dwordx4 v6, s[8:11], s4 offen offset:2048 nt lds
    s_waitcnt vmcnt(4)
    buffer_load_dwordx4 v7, s[8:11], s4 offen offset:3072 nt lds
    s_and_b32 s4, s5, 0xffffff
    s_add_u32 m0, s29, 8192
    s_add_u32 s5, s5, 0x80000
    s_waitcnt vmcnt(4)
    buffer_load_dwordx4 v4, s[8:11], s4 offen offset:0 nt lds
    s_waitcnt vmcnt(4)
    buffer_load_dwordx4 v5, s[8:11], s4 offen offset:1024 nt lds
    s_waitcnt vmcnt(4)
    buffer_load_dwordx4 v6, s[8:11], s4 offen offset:2048 nt lds
    s_waitcnt vmcnt(4)
    buffer_load_dwordx4 v7, s[8:11], s4 offen offset:3072 nt lds
    s_and_b32 s4, s5, 0xffffff
    s_add_u32 m0, s29, 24576
    s_add_u32 s5, s5, 0x80000
    s_waitcnt vmcnt(4)
    buffer_load_dwordx4 v4, s[8:11], s4 offen offset:0 nt lds
    s_waitcnt vmcnt(4)
    buffer_load_dwordx4 v5, s[8:11], s4 offen offset:1024 nt lds
    s_waitcnt vmcnt(4)
    buffer_load_dwordx4 v6, s[8:11], s4 offen offset:2048 nt lds
    s_waitcnt vmcnt(4)
    buffer_load_dwordx4 v7, s[8:11], s4 offen offset:3072 nt lds
    s_and_b32 s4, s5, 0xffffff
    s_add_u32 m0, s29, 12288
    s_add_u32 s5, s5, 0x80000
    s_waitcnt vmcnt(4)
    buffer_load_dwordx4 v4, s[8:11], s4 offen offset:0 nt lds
    s_waitcnt vmcnt(4)
    buffer_load_dwordx4 v5, s[8:11], s4 offen offset:1024 nt lds
    s_waitcnt vmcnt(4)
    buffer_load_dwordx4 v6, s[8:11], s4 offen offset:2048 nt lds
    s_waitcnt vmcnt(4)
    buffer_load_dwordx4 v7, s[8:11], s4 offen offset:3072 nt lds
    s_and_b32 s4, s5, 0xffffff
    s_add_u32 m0, s29, 28672
    s_add_u32 s5, s5, 0x80000
    s_waitcnt vmcnt(4)
    buffer_load_dwordx4 v4, s[8:11], s4 offen offset:0 nt lds
    s_waitcnt vmcnt(4)
    buffer_load_dwordx4 v5, s[8:11], s4 offen offset:1024 nt lds
    s_waitcnt vmcnt(4)
    buffer_load_dwordx4 v6, s[8:11], s4 offen offset:2048 nt lds
    s_waitcnt vmcnt(4)
    buffer_load_dwordx4 v7, s[8:11], s4 offen offset:3072 nt lds
    v_bfe_u32 v3, v0, 2, 2
    v_lshlrev_b32 v3, 8, v3
    v_lshl_or_b32 v3, v1, 4, v3
    v_add_u32 v3, 148480, v3
    v_mov_b32 v84, 150144
    v_mov_b32 v207, 150144
    v_mov_b32 v208, 1
    s_mov_b32 s56, 0x3db504f3
    s_mov_b32 s57, s56
    s_mov_b32 s58, 0
    s_mov_b32 s59, s29
    s_mov_b32 s63, 4
    s_mov_b32 s40, 0xffc00000
    s_mov_b32 s41, 0xfffff
    s_cmp_lt_u32 s26, 8
    s_cselect_b32 s61, 30, 30
    s_cselect_b32 s40, 0xffc00000, s40
    s_cselect_b32 s41, 0xfffff, s41
    s_mov_b32 s60, s61
    s_and_b32 s62, s61, 2
    s_lshl_b32 s62, s62, 12
    v_xor_b32 v14, 8192, v14
    v_xor_b32 v15, 8192, v15
    v_xor_b32 v16, 8192, v16
    v_xor_b32 v17, 8192, v17
    v_xor_b32 v18, 8192, v18
    v_xor_b32 v19, 8192, v19
    v_xor_b32 v20, 8192, v20
    v_xor_b32 v21, 8192, v21
    s_mov_b32 s95, s61
    s_mov_b32 s31, 0x400000
L_wq:
    ds_read_b64 v[82:83], v84
    s_waitcnt lgkmcnt(0)
    v_readfirstlane_b32 s3, v83
    v_readfirstlane_b32 s30, v82
    s_cmp_lg_u32 s3, 0
    s_cbranch_scc1 L_wq_done
    s_sleep 2
    s_sub_u32 s31, s31, 1
    s_cbranch_scc0 L_wq
L_wq_done:
    ds_read_b128 v[24:27], v3 offset:0
    ds_read_b128 v[28:31], v3 offset:64
    ds_read_b128 v[32:35], v3 offset:128
    ds_read_b128 v[36:39], v3 offset:192
    s_mul_i32 s3, s30, 0x85ebca6b
    s_xor_b32 s3, s3, 0x5a5aa5a5
    v_mov_b32 v82, s30
    v_mov_b32 v83, s3
    v_and_b32 v201, 8, v0
    v_cmp_eq_u32 vcc, 8, v201
    v_and_b32 v202, 7, v0
    v_lshlrev_b32 v202, 2, v202
    v_cndmask_b32 v201, v82, v83, vcc
    v_and_b32 v203, 2, v0
    v_cmp_eq_u32 vcc, 2, v203
    v_lshrrev_b32 v201, v202, v201
    v_lshrrev_b32 v202, 4, v201
    v_and_b32 v204, 1, v0
    v_lshlrev_b32 v204, 4, v204
    v_cndmask_b32 v203, v82, v83, vcc
    v_lshrrev_b32 v203, v204, v203
    v_bfe_u32 v206, v203, 12, 4
    v_bfe_u32 v205, v203, 8, 4
    v_bfe_u32 v204, v203, 4, 4
    v_bfe_u32 v203, v203, 0, 4
    s_waitcnt lgkmcnt(0)
L_a:
    s_waitcnt vmcnt(12)
    ds_read_b128 v[40:43], v10
    ds_read_b128 v[44:47], v11
    ds_read_b128 v[48:51], v12
    ds_read_b128 v[52:55], v13
    s_mov_b32 m0, s59
    s_cmp_lg_u32 s58, 0
    s_waitcnt lgkmcnt(3)
    v_mfma_f32_16x16x32_bf16 v[72:75], v[40:43], v[24:27], 0
    s_waitcnt lgkmcnt(2)
    v_mfma_f32_16x16x32_bf16 v[72:75], v[44:47], v[28:31], v[72:75]
    s_waitcnt lgkmcnt(1)
    v_mfma_f32_16x16x32_bf16 v[72:75], v[48:51], v[32:35], v[72:75]
    s_waitcnt lgkmcnt(0)
    v_mfma_f32_16x16x32_bf16 v[72:75], v[52:55], v[36:39], v[72:75]
    s_cbranch_scc1 L_ai
    s_bitcmp1_b32 s40, 0
    s_cbranch_scc1 L_av
    s_and_b32 s4, s5, 0xffffff
    s_add_u32 s5, s5, 0x80000
    s_waitcnt vmcnt(4)
    buffer_load_dwordx4 v4, s[8:11], s4 offen offset:0 nt lds
    s_waitcnt vmcnt(4)
    buffer_load_dwordx4 v5, s[8:11], s4 offen offset:1024 nt lds
    s_waitcnt vmcnt(4)
    buffer_load_dwordx4 v6, s[8:11], s4 offen offset:2048 nt lds
    s_waitcnt vmcnt(5)
    buffer_load_dwordx4 v7, s[8:11], s4 offen offset:3072 nt lds
    s_branch L_ad
L_av:
    s_and_b32 s4, s92, 0xffffff
    s_add_u32 s92, s92, 0x80000
    s_waitcnt vmcnt(4)
    buffer_load_dwordx4 v8, s[12:15], s4 offen offset:0 nt lds
    s_waitcnt vmcnt(4)
    buffer_load_dwordx4 v9, s[12:15], s4 offen offset:1024 nt lds
    s_waitcnt vmcnt(4)
    buffer_load_dwordx4 v8, s[12:15], s4 offen offset:2048 nt lds
    s_waitcnt vmcnt(5)
    buffer_load_dwordx4 v9, s[12:15], s4 offen offset:3072 nt lds
L_ad:
    s_lshr_b64 s[40:41], s[40:41], 1
L_ai:
    s_add_u32 s3, s59, 0x1000
    s_xor_b32 s3, s3, s59
    s_and_b32 s3, s3, 0x3000
    s_lshl_b32 s7, s58, 14
    s_or_b32 s3, s3, s7
    s_cmp_lg_u32 s63, s58
    s_cselect_b32 s7, 1, 0
    s_sub_u32 s63, s63, s58
    s_andn2_b32 s58, s7, s58
    s_cselect_b32 s3, 0x4000, s3
    v_cvt_pk_bf16_f32 v82, v72, v73
    v_cvt_pk_bf16_f32 v83, v74, v75
    v_lshlrev_b32 v72, 16, v82
    v_and_b32 v73, 0xffff0000, v82
    v_lshlrev_b32 v74, 16, v83
    v_and_b32 v75, 0xffff0000, v83
    v_pk_mul_f32 v[72:73], v[72:73], s[56:57]
    v_pk_mul_f32 v[74:75], v[74:75], s[56:57]
    v_xor_b32 v10, s3, v10
    v_xor_b32 v11, s3, v11
    v_xor_b32 v12, s3, v12
    v_xor_b32 v13, s3, v13
    v_cvt_pk_bf16_f32 v82, v72, v73
    v_cvt_pk_bf16_f32 v83, v74, v75
    v_max3_f32 v78, v72, v73, v78
    v_max3_f32 v78, v74, v75, v78
    s_mov_b32 exec_lo, 0x11111111
    s_mov_b32 exec_hi, 0x11111111
    ds_write_b64 v86, v[82:83]
    s_mov_b64 exec, -1
    s_xor_b32 s59, s59, s3
    v_add_u32 v86, 128, v86
    s_sub_u32 s60, s60, 1
    s_cmp_lg_u32 s60, 0
    s_cbranch_scc1 L_a
    s_mov_b64 exec, 1
    ds_add_u32 v207, v208 offset:32
    s_mov_b64 exec, -1
    v_mov_b32 v83, v78
    s_nop 1
    v_permlane16_swap_b32 v83, v78
    v_max_f32 v78, v83, v78
    v_mov_b32 v83, v78
    s_nop 1
    v_permlane32_swap_b32 v83, v78
    v_max_f32 v78, v83, v78
    s_lshl_b32 s3, s61, 7
    v_subrev_u32 v86, s3, v86
    v_cvt_pk_bf16_f32 v78, v78, v78
    s_mov_b32 s60, s61
    s_add_u32 s61, s29, 0
    s_mov_b32 s63, 0
    v_xor_b32 v10, 8192, v10
    v_xor_b32 v11, 8192, v11
    v_xor_b32 v12, 8192, v12
    v_xor_b32 v13, 8192, v13
    v_lshlrev_b32 v78, 16, v78
    v_mul_f32 v81, s6, v78
L_c:
    ds_read_b64 v[82:83], v86
    s_cmp_eq_u32 s58, s60
    s_cbranch_scc1 L_el
    s_waitcnt vmcnt(8)
    ds_read_b64_tr_b16 v[56:57], v14
    ds_read_b64_tr_b16 v[58:59], v15
    ds_read_b64_tr_b16 v[60:61], v16
    ds_read_b64_tr_b16 v[62:63], v17
    ds_read_b64_tr_b16 v[64:65], v18
    ds_read_b64_tr_b16 v[66:67], v19
    ds_read_b64_tr_b16 v[68:69], v20
    ds_read_b64_tr_b16 v[70:71], v21
    s_mov_b32 m0, s59
    s_add_u32 s3, s59, 0x1000
    s_xor_b32 s3, s3, s59
    s_and_b32 s3, s3, 0x3000
    s_xor_b32 s59, s59, s3
    v_add_u32 v86, 128, v86
    s_waitcnt lgkmcnt(8)
    v_lshlrev_b32 v72, 16, v82
    v_and_b32 v73, 0xffff0000, v82
    v_lshlrev_b32 v74, 16, v83
    v_and_b32 v75, 0xffff0000, v83
    v_fma_f32 v72, v72, s6, -v81
    v_fma_f32 v73, v73, s6, -v81
    v_fma_f32 v74, v74, s6, -v81
    v_fma_f32 v75, v75, s6, -v81
    v_exp_f32 v72, v72
    v_exp_f32 v73, v73
    v_exp_f32 v74, v74
    v_exp_f32 v75, v75
    v_xor_b32 v14, s3, v14
    v_xor_b32 v15, s3, v15
    v_xor_b32 v16, s3, v16
    v_xor_b32 v17, s3, v17
    v_xor_b32 v18, s3, v18
    v_xor_b32 v19, s3, v19
    v_xor_b32 v20, s3, v20
    v_xor_b32 v21, s3, v21
    v_cvt_pk_bf16_f32 v76, v72, v73
    v_cvt_pk_bf16_f32 v77, v74, v75
    v_add_f32 v82, v72, v73
    v_add_f32 v83, v74, v75
    v_add_f32 v79, v79, v82
    v_add_f32 v79, v79, v83
    s_waitcnt lgkmcnt(7)
    v_mfma_f32_16x16x16_bf16 v[88:91], v[76:77], v[56:57], v[88:91]
    s_waitcnt lgkmcnt(6)
    v_mfma_f32_16x16x16_bf16 v[92:95], v[76:77], v[58:59], v[92:95]
    s_waitcnt lgkmcnt(5)
    v_mfma_f32_16x16x16_bf16 v[96:99], v[76:77], v[60:61], v[96:99]
    s_waitcnt lgkmcnt(4)
    v_mfma_f32_16x16x16_bf16 v[100:103], v[76:77], v[62:63], v[100:103]
    s_waitcnt lgkmcnt(3)
    v_mfma_f32_16x16x16_bf16 v[104:107], v[76:77], v[64:65], v[104:107]
    s_waitcnt lgkmcnt(2)
    v_mfma_f32_16x16x16_bf16 v[108:111], v[76:77], v[66:67], v[108:111]
    s_waitcnt lgkmcnt(1)
    v_mfma_f32_16x16x16_bf16 v[112:115], v[76:77], v[68:69], v[112:115]
    s_waitcnt lgkmcnt(0)
    s_cmp_le_u32 s60, 4
    v_mfma_f32_16x16x16_bf16 v[116:119], v[76:77], v[70:71], v[116:119]
    s_cbranch_scc1 L_er
    s_bitcmp1_b32 s40, 0
    s_cbranch_scc1 L_cv
    s_and_b32 s4, s5, 0xffffff
    s_add_u32 s5, s5, 0x80000
    s_waitcnt vmcnt(4)
    buffer_load_dwordx4 v4, s[8:11], s4 offen offset:0 nt lds
    s_waitcnt vmcnt(4)
    buffer_load_dwordx4 v5, s[8:11], s4 offen offset:1024 nt lds
    s_waitcnt vmcnt(4)
    buffer_load_dwordx4 v6, s[8:11], s4 offen offset:2048 nt lds
    s_waitcnt vmcnt(5)
    buffer_load_dwordx4 v7, s[8:11], s4 offen offset:3072 nt lds
    s_branch L_cd
L_cv:
    s_and_b32 s4, s92, 0xffffff
    s_add_u32 s92, s92, 0x80000
    s_cmp_lg_u64 s[40:41], 1
    s_cbranch_scc1 L_cn
    v_mov_b32 v22, 1
    buffer_atomic_add v22, v85, s[20:23], 0 offen sc0
L_cn:
    s_waitcnt vmcnt(4)
    buffer_load_dwordx4 v8, s[12:15], s4 offen offset:0 nt lds
    s_waitcnt vmcnt(4)
    buffer_load_dwordx4 v9, s[12:15], s4 offen offset:1024 nt lds
    s_waitcnt vmcnt(4)
    buffer_load_dwordx4 v8, s[12:15], s4 offen offset:2048 nt lds
    s_waitcnt vmcnt(5)
    buffer_load_dwordx4 v9, s[12:15], s4 offen offset:3072 nt lds
L_cd:
    s_lshr_b64 s[40:41], s[40:41], 1
L_ex:
    s_sub_u32 s60, s60, 1
    s_cmp_lg_u32 s60, 0
    s_cbranch_scc1 L_c
    s_cmp_lg_u32 s58, 0
    s_cbranch_scc0 L_e2
    s_waitcnt vmcnt(4)
    s_branch L_k
L_el:
    v_subrev_u32 v14, 4096, v14
    v_subrev_u32 v15, 4096, v15
    v_subrev_u32 v16, 4096, v16
    v_subrev_u32 v17, 4096, v17
    v_subrev_u32 v18, 4096, v18
    v_subrev_u32 v19, 4096, v19
    v_subrev_u32 v20, 4096, v20
    v_subrev_u32 v21, 4096, v21
    s_waitcnt lgkmcnt(0)
    v_lshlrev_b32 v72, 16, v82
    v_and_b32 v73, 0xffff0000, v82
    v_lshlrev_b32 v74, 16, v83
    v_and_b32 v75, 0xffff0000, v83
    v_fma_f32 v72, v72, s6, -v81
    v_fma_f32 v73, v73, s6, -v81
    v_fma_f32 v74, v74, s6, -v81
    v_fma_f32 v75, v75, s6, -v81
    v_exp_f32 v72, v72
    v_exp_f32 v73, v73
    v_exp_f32 v74, v74
    v_exp_f32 v75, v75
    s_mov_b32 s3, s92
    v_cvt_pk_bf16_f32 v76, v72, v73
    v_cvt_pk_bf16_f32 v77, v74, v75
    s_branch L_last2
L_ef:
    s_mov_b32 s92, s3
    s_cmp_eq_u32 s60, 3
    s_cselect_b32 s58, 1, 2
    s_mov_b64 exec, 1
    ds_add_u32 v207, v208 offset:24
    s_mov_b64 exec, -1
    s_branch L_ex
L_ev:
    s_add_u32 m0, s61, 0x1000
    s_xor_b32 s61, s61, 0x2000
    s_cmp_lg_u32 s63, 0
    s_cbranch_scc1 L_ev2
    s_waitcnt vmcnt(6)
    buffer_load_dwordx4 v8, s[12:15], s4 offen offset:0 nt lds
    s_waitcnt vmcnt(6)
    buffer_load_dwordx4 v9, s[12:15], s4 offen offset:1024 nt lds
    s_waitcnt vmcnt(6)
    buffer_load_dwordx4 v8, s[12:15], s4 offen offset:2048 nt lds
    s_waitcnt vmcnt(6)
    buffer_load_dwordx4 v9, s[12:15], s4 offen offset:3072 nt lds
    s_branch L_ex
L_ev2:
    buffer_load_dwordx4 v8, s[12:15], s4 offen offset:0 nt lds
    buffer_load_dwordx4 v9, s[12:15], s4 offen offset:1024 nt lds
    buffer_load_dwordx4 v8, s[12:15], s4 offen offset:2048 nt lds
    buffer_load_dwordx4 v9, s[12:15], s4 offen offset:3072 nt lds
    s_branch L_ex
L_ek2:
    buffer_load_dwordx4 v4, s[8:11], s4 offen offset:0 nt lds
    buffer_load_dwordx4 v5, s[8:11], s4 offen offset:1024 nt lds
    buffer_load_dwordx4 v6, s[8:11], s4 offen offset:2048 nt lds
    buffer_load_dwordx4 v7, s[8:11], s4 offen offset:3072 nt lds
    s_branch L_ey
L_er:
    s_cmp_lg_u32 s58, 0
    s_cbranch_scc1 L_ex
    s_cmp_eq_u32 s60, 4
    s_cbranch_scc1 L_ex
    s_cmp_eq_u32 s60, 2
    s_cbranch_scc1 L_ev
    s_cmp_eq_u32 s60, 1
    s_mov_b32 m0, s61
    s_cbranch_scc1 L_e3
    s_waitcnt vmcnt(4)
L_e3:
    v_readfirstlane_b32 s3, v22
    s_cmp_ge_u32 s3, 64
    s_cbranch_scc1 L_ef
    v_mov_b32 v22, 1
    buffer_atomic_add v22, v85, s[20:23], 0 offen sc0
    s_lshl_b32 s4, s3, 14
    s_add_u32 s4, s4, s27
    s_and_b32 s4, s4, 0xffffff
    s_cmp_ge_u32 s3, 48
    s_cselect_b32 s63, 1, 0
    s_cbranch_scc1 L_ek2
    s_waitcnt vmcnt(6)
    buffer_load_dwordx4 v4, s[8:11], s4 offen offset:0 nt lds
    s_waitcnt vmcnt(6)
    buffer_load_dwordx4 v5, s[8:11], s4 offen offset:1024 nt lds
    s_waitcnt vmcnt(6)
    buffer_load_dwordx4 v6, s[8:11], s4 offen offset:2048 nt lds
    s_waitcnt vmcnt(6)
    buffer_load_dwordx4 v7, s[8:11], s4 offen offset:3072 nt lds
L_ey:
    s_cmp_eq_u32 s60, 1
    s_cbranch_scc1 L_ev
    s_branch L_ex
L_e2:
    s_mov_b32 s58, 1
    s_waitcnt vmcnt(13)
    s_branch L_k
L_lz:
    buffer_load_dwordx4 v4, s[8:11], s4 offen offset:0 nt lds
    buffer_load_dwordx4 v5, s[8:11], s4 offen offset:1024 nt lds
    buffer_load_dwordx4 v6, s[8:11], s4 offen offset:2048 nt lds
    buffer_load_dwordx4 v7, s[8:11], s4 offen offset:3072 nt lds
    s_add_u32 m0, m0, 4096
    s_nop 0
    buffer_load_dwordx4 v8, s[12:15], s4 offen offset:0 nt lds
    buffer_load_dwordx4 v9, s[12:15], s4 offen offset:1024 nt lds
    buffer_load_dwordx4 v8, s[12:15], s4 offen offset:2048 nt lds
    buffer_load_dwordx4 v9, s[12:15], s4 offen offset:3072 nt lds
    s_branch L_v
L_rs:
    v_mov_b32 v83, v82
    s_nop 1
    v_permlane16_swap_b32 v83, v82
    v_max_f32 v82, v83, v82
    v_mov_b32 v83, v82
    s_nop 1
    v_permlane32_swap_b32 v83, v82
    v_max_f32 v82, v83, v82
    v_sub_f32 v80, v78, v82
    v_mul_f32 v81, s6, v82
    v_mul_f32 v80, s6, v80
    v_exp_f32 v80, v80
    v_mov_b32 v78, v82
    v_mul_f32 v79, v80, v79
    s_nop 0
    v_mov_b32_dpp v83, v80 row_newbcast:0 row_mask:0x1 bank_mask:0xf
    v_mov_b32_dpp v83, v80 row_newbcast:4 row_mask:0x2 bank_mask:0xf
    v_mov_b32_dpp v83, v80 row_newbcast:8 row_mask:0x4 bank_mask:0xf
    v_mov_b32_dpp v83, v80 row_newbcast:12 row_mask:0x8 bank_mask:0xf
    v_mul_f32 v88, v83, v88
    v_mul_f32 v92, v83, v92
    v_mul_f32 v96, v83, v96
    v_mul_f32 v100, v83, v100
    v_mul_f32 v104, v83, v104
    v_mul_f32 v108, v83, v108
    v_mul_f32 v112, v83, v112
    v_mul_f32 v116, v83, v116
    s_branch L_ns
L_loop:
    s_waitcnt vmcnt(4)
L_k:
    ds_read_b128 v[40:43], v10
    ds_read_b128 v[44:47], v11
    ds_read_b128 v[48:51], v12
    ds_read_b128 v[52:55], v13
    s_xor_b32 m0, s59, 0x2000
    s_cmp_lg_u32 s58, 0
    s_waitcnt lgkmcnt(3)
    v_mfma_f32_16x16x32_bf16 v[72:75], v[40:43], v[24:27], 0
    s_waitcnt lgkmcnt(2)
    v_mfma_f32_16x16x32_bf16 v[72:75], v[44:47], v[28:31], v[72:75]
    s_waitcnt lgkmcnt(1)
    v_mfma_f32_16x16x32_bf16 v[72:75], v[48:51], v[32:35], v[72:75]
    s_waitcnt lgkmcnt(0)
    v_mfma_f32_16x16x32_bf16 v[72:75], v[52:55], v[36:39], v[72:75]
    s_nop 7
    v_cvt_pk_bf16_f32 v82, v72, v73
    v_cvt_pk_bf16_f32 v83, v74, v75
    v_lshlrev_b32 v72, 16, v82
    v_and_b32 v73, 0xffff0000, v82
    v_lshlrev_b32 v74, 16, v83
    v_and_b32 v75, 0xffff0000, v83
    v_pk_mul_f32 v[72:73], v[72:73], s[56:57]
    v_pk_mul_f32 v[74:75], v[74:75], s[56:57]
    v_cvt_pk_bf16_f32 v82, v72, v73
    v_cvt_pk_bf16_f32 v83, v74, v75
    v_lshlrev_b32 v72, 16, v82
    v_and_b32 v73, 0xffff0000, v82
    v_lshlrev_b32 v74, 16, v83
    v_and_b32 v75, 0xffff0000, v83
    v_max3_f32 v82, v72, v73, v74
    v_max3_f32 v82, v82, v75, v78
    v_cmp_gt_f32 vcc, v82, v78
    s_cbranch_vccnz L_rs
L_ns:
    v_fma_f32 v72, v72, s6, -v81
    v_fma_f32 v73, v73, s6, -v81
    v_fma_f32 v74, v74, s6, -v81
    v_fma_f32 v75, v75, s6, -v81
    v_exp_f32 v72, v72
    v_exp_f32 v73, v73
    v_exp_f32 v74, v74
    v_exp_f32 v75, v75
    s_cmp_lg_u32 s58, 0
    v_cvt_pk_bf16_f32 v76, v72, v73
    v_cvt_pk_bf16_f32 v77, v74, v75
    s_cbranch_scc1 L_nr
    v_readfirstlane_b32 s3, v22
    s_cmp_ge_u32 s3, 64
    s_cbranch_scc1 L_last
    v_mov_b32 v22, 1
    buffer_atomic_add v22, v85, s[20:23], 0 offen sc0
    s_sub_u32 s7, s3, 48
    s_lshl_b32 s3, s3, 14
    s_add_u32 s3, s3, s27
    s_and_b32 s4, s3, 0xffffff
    s_cmp_ge_i32 s7, 0
    s_cbranch_scc1 L_lz
    buffer_load_dwordx4 v4, s[8:11], s4 offen offset:0 nt lds
    buffer_load_dwordx4 v5, s[8:11], s4 offen offset:1024 nt lds
    s_waitcnt vmcnt(6)
    buffer_load_dwordx4 v6, s[8:11], s4 offen offset:2048 nt lds
    s_waitcnt vmcnt(6)
    buffer_load_dwordx4 v7, s[8:11], s4 offen offset:3072 nt lds
    s_add_u32 m0, m0, 4096
    s_waitcnt vmcnt(6)
    buffer_load_dwordx4 v8, s[12:15], s4 offen offset:0 nt lds
    s_waitcnt vmcnt(6)
    buffer_load_dwordx4 v9, s[12:15], s4 offen offset:1024 nt lds
    s_waitcnt vmcnt(6)
    buffer_load_dwordx4 v8, s[12:15], s4 offen offset:2048 nt lds
    s_waitcnt vmcnt(6)
    buffer_load_dwordx4 v9, s[12:15], s4 offen offset:3072 nt lds
L_v:
    s_waitcnt vmcnt(9)
    ds_read_b64_tr_b16 v[56:57], v14 offset:4096
    ds_read_b64_tr_b16 v[58:59], v15 offset:4096
    ds_read_b64_tr_b16 v[60:61], v16 offset:4096
    ds_read_b64_tr_b16 v[62:63], v17 offset:4096
    ds_read_b64_tr_b16 v[64:65], v18 offset:4096
    ds_read_b64_tr_b16 v[66:67], v19 offset:4096
    ds_read_b64_tr_b16 v[68:69], v20 offset:4096
    ds_read_b64_tr_b16 v[70:71], v21 offset:4096
    v_add_f32 v82, v72, v73
    v_add_f32 v83, v74, v75
    v_add_f32 v79, v79, v82
    v_add_f32 v79, v79, v83
    s_waitcnt lgkmcnt(7)
    v_mfma_f32_16x16x16_bf16 v[88:91], v[76:77], v[56:57], v[88:91]
    s_waitcnt lgkmcnt(6)
    v_mfma_f32_16x16x16_bf16 v[92:95], v[76:77], v[58:59], v[92:95]
    s_waitcnt lgkmcnt(5)
    v_mfma_f32_16x16x16_bf16 v[96:99], v[76:77], v[60:61], v[96:99]
    s_waitcnt lgkmcnt(4)
    v_mfma_f32_16x16x16_bf16 v[100:103], v[76:77], v[62:63], v[100:103]
    s_waitcnt lgkmcnt(3)
    v_mfma_f32_16x16x16_bf16 v[104:107], v[76:77], v[64:65], v[104:107]
    s_waitcnt lgkmcnt(2)
    v_mfma_f32_16x16x16_bf16 v[108:111], v[76:77], v[66:67], v[108:111]
    s_waitcnt lgkmcnt(1)
    v_mfma_f32_16x16x16_bf16 v[112:115], v[76:77], v[68:69], v[112:115]
    s_waitcnt lgkmcnt(0)
    v_mfma_f32_16x16x16_bf16 v[116:119], v[76:77], v[70:71], v[116:119]
    v_xor_b32 v10, 0x2000, v10
    v_xor_b32 v11, 0x2000, v11
    v_xor_b32 v12, 0x2000, v12
    v_xor_b32 v13, 0x2000, v13
    v_xor_b32 v14, 0x2000, v14
    v_xor_b32 v15, 0x2000, v15
    v_xor_b32 v16, 0x2000, v16
    v_xor_b32 v17, 0x2000, v17
    v_xor_b32 v18, 0x2000, v18
    v_xor_b32 v19, 0x2000, v19
    v_xor_b32 v20, 0x2000, v20
    v_xor_b32 v21, 0x2000, v21
    s_xor_b32 s59, s59, 0x2000
    s_branch L_loop
L_nr:
    s_cmp_eq_u32 s58, 1
    s_mov_b32 s58, 0
    s_cbranch_scc1 L_v
    s_mov_b32 s3, s92
    s_branch L_last2
L_last:
    s_mov_b64 exec, 1
    ds_add_u32 v207, v208 offset:24
    s_mov_b64 exec, -1
L_last2:
    v_add_f32 v82, v72, v73
    v_add_f32 v83, v74, v75
    v_add_f32 v79, v79, v82
    v_add_f32 v79, v79, v83
    v_mov_b32 v83, v79
    s_nop 1
    v_permlane16_swap_b32 v83, v79
    v_add_f32 v79, v83, v79
    v_mov_b32 v83, v79
    s_nop 1
    v_permlane32_swap_b32 v83, v79
    v_add_f32 v79, v83, v79
    s_mov_b64 exec, 0x1111
    ds_write_b64 v185, v[78:79]
    s_mov_b64 exec, 1
    ds_add_rtn_u32 v84, v207, v208 offset:40
    s_mov_b64 exec, -1
    ds_read_b64 v[48:49], v187
    v_xor_b32 v219, 32, v187
    v_xor_b32 v220, 64, v187
    v_xor_b32 v221, 96, v187
    ds_read_b64 v[50:51], v219
    ds_read_b64 v[52:53], v220
    ds_read_b64 v[54:55], v221
    v_xor_b32 v219, 4096, v184
    v_xor_b32 v220, 8192, v184
    v_xor_b32 v221, 12288, v184
    v_mov_b32 v7, s30
    v_mov_b32 v13, s30
    s_movk_i32 s4, 8320
    s_waitcnt lgkmcnt(4)
    v_readfirstlane_b32 s60, v84
    s_waitcnt lgkmcnt(0)
    v_max3_f32 v82, v48, v50, v52
    v_max_f32 v82, v82, v54
    v_sub_f32 v48, v48, v82
    v_sub_f32 v50, v50, v82
    v_sub_f32 v52, v52, v82
    v_sub_f32 v54, v54, v82
    v_mul_f32 v48, s6, v48
    v_mul_f32 v50, s6, v50
    v_mul_f32 v52, s6, v52
    v_mul_f32 v54, s6, v54
    v_exp_f32 v48, v48
    v_exp_f32 v50, v50
    v_exp_f32 v52, v52
    v_exp_f32 v54, v54
    s_cmp_lg_u32 s60, 3
    v_mul_f32 v83, v48, v49
    v_fmac_f32 v83, v50, v51
    v_fmac_f32 v83, v52, v53
    v_fmac_f32 v83, v54, v55
    s_cselect_b64 vcc, -1, 0
    v_rcp_f32 v84, v83
    v_log_f32 v6, v83
    v_mul_f32 v48, v84, v48
    v_mul_f32 v50, v84, v50
    v_mul_f32 v52, v84, v52
    v_mul_f32 v54, v84, v54
    v_fmac_f32 v6, s6, v82
    v_cndmask_b32 v48, v48, 1.0, vcc
    v_mov_b32 v12, v6
    s_waitcnt vmcnt(0)
L_vl:
    ds_read_b64_tr_b16 v[56:57], v14 offset:4096
    ds_read_b64_tr_b16 v[58:59], v15 offset:4096
    ds_read_b64_tr_b16 v[60:61], v16 offset:4096
    ds_read_b64_tr_b16 v[62:63], v17 offset:4096
    ds_read_b64_tr_b16 v[64:65], v18 offset:4096
    ds_read_b64_tr_b16 v[66:67], v19 offset:4096
    ds_read_b64_tr_b16 v[68:69], v20 offset:4096
    ds_read_b64_tr_b16 v[70:71], v21 offset:4096
    ds_read_b32 v209, v207 offset:16
    ds_read_b128 v[24:27], v219 offset:0
    ds_read_b128 v[28:31], v219 offset:1024
    ds_read_b128 v[32:35], v220 offset:0
    ds_read_b128 v[36:39], v220 offset:1024
    ds_read_b128 v[40:43], v221 offset:0
    ds_read_b128 v[44:47], v221 offset:1024
    s_waitcnt lgkmcnt(14)
    v_mfma_f32_16x16x16_bf16 v[88:91], v[76:77], v[56:57], v[88:91]
    s_waitcnt lgkmcnt(13)
    v_mfma_f32_16x16x16_bf16 v[92:95], v[76:77], v[58:59], v[92:95]
    s_waitcnt lgkmcnt(12)
    v_mfma_f32_16x16x16_bf16 v[96:99], v[76:77], v[60:61], v[96:99]
    s_waitcnt lgkmcnt(11)
    v_mfma_f32_16x16x16_bf16 v[100:103], v[76:77], v[62:63], v[100:103]
    s_waitcnt lgkmcnt(10)
    v_mfma_f32_16x16x16_bf16 v[104:107], v[76:77], v[64:65], v[104:107]
    v_mul_f32 v210, v48, v88
    s_waitcnt lgkmcnt(9)
    v_mfma_f32_16x16x16_bf16 v[108:111], v[76:77], v[66:67], v[108:111]
    v_mul_f32 v211, v48, v92
    s_waitcnt lgkmcnt(8)
    v_mfma_f32_16x16x16_bf16 v[112:115], v[76:77], v[68:69], v[112:115]
    v_mul_f32 v212, v48, v96
    s_waitcnt lgkmcnt(7)
    v_mfma_f32_16x16x16_bf16 v[116:119], v[76:77], v[70:71], v[116:119]
    v_mul_f32 v213, v48, v100
    v_mul_f32 v214, v48, v104
    s_waitcnt lgkmcnt(6)
    v_readfirstlane_b32 s3, v209
    v_mul_f32 v215, v48, v108
    s_cmp_lg_u32 s60, 3
    v_mul_f32 v216, v48, v112
    s_nop 0
    v_mul_f32 v217, v48, v116
    s_cbranch_scc1 L_dep
    s_cmp_ge_u32 s3, 3
    s_cbranch_scc0 L_slow
L_add:
    s_waitcnt lgkmcnt(5)
    v_pk_fma_f32 v[210:211], v[24:25], v[50:51], v[210:211] op_sel_hi:[1,0,1]
    v_pk_fma_f32 v[212:213], v[26:27], v[50:51], v[212:213] op_sel_hi:[1,0,1]
    s_waitcnt lgkmcnt(4)
    v_pk_fma_f32 v[214:215], v[28:29], v[50:51], v[214:215] op_sel_hi:[1,0,1]
    v_pk_fma_f32 v[216:217], v[30:31], v[50:51], v[216:217] op_sel_hi:[1,0,1]
    s_waitcnt lgkmcnt(3)
    v_pk_fma_f32 v[210:211], v[32:33], v[52:53], v[210:211] op_sel_hi:[1,0,1]
    v_pk_fma_f32 v[212:213], v[34:35], v[52:53], v[212:213] op_sel_hi:[1,0,1]
    s_waitcnt lgkmcnt(2)
    v_pk_fma_f32 v[214:215], v[36:37], v[52:53], v[214:215] op_sel_hi:[1,0,1]
    v_pk_fma_f32 v[216:217], v[38:39], v[52:53], v[216:217] op_sel_hi:[1,0,1]
    s_waitcnt lgkmcnt(1)
    v_pk_fma_f32 v[210:211], v[40:41], v[54:55], v[210:211] op_sel_hi:[1,0,1]
    v_pk_fma_f32 v[212:213], v[42:43], v[54:55], v[212:213] op_sel_hi:[1,0,1]
    v_cvt_pk_bf16_f32 v4, v210, v211
    v_cvt_pk_bf16_f32 v5, v212, v213
    buffer_store_dwordx4 v[4:7], v188, s[20:23], 0 offen sc1
    s_waitcnt lgkmcnt(0)
    v_pk_fma_f32 v[214:215], v[44:45], v[54:55], v[214:215] op_sel_hi:[1,0,1]
    v_pk_fma_f32 v[216:217], v[46:47], v[54:55], v[216:217] op_sel_hi:[1,0,1]
    v_cvt_pk_bf16_f32 v10, v214, v215
    v_cvt_pk_bf16_f32 v11, v216, v217
    buffer_store_dwordx4 v[10:13], v188, s[20:23], s4 offen sc1
    s_cmp_ge_u32 s26, 16
    s_cbranch_scc1 L_fin
    s_waitcnt vmcnt(0)
    s_mov_b64 exec, 1
    ds_add_u32 v207, v208 offset:16
    s_mov_b64 exec, -1
L_hop:
    s_mov_b32 s94, 0
    s_mov_b32 s31, 0x40000
    s_waitcnt vmcnt(0)
    buffer_load_dwordx4 v[56:59], v189, s[20:23], 0 offen offset:0 sc1
    buffer_load_dwordx4 v[60:63], v189, s[20:23], 0 offen offset:256 sc1
    s_branch L_p1_w
L_p1:
    buffer_load_dwordx4 v[56:59], v189, s[20:23], 0 offen offset:0 sc1
    buffer_load_dwordx4 v[60:63], v189, s[20:23], 0 offen offset:256 sc1
L_p1_w:
    s_cmp_lg_u32 s94, 0
    s_cbranch_scc1 L_wt
    ds_read_b32 v209, v207 offset:36
    s_waitcnt lgkmcnt(0)
    v_readfirstlane_b32 s94, v209
    s_cmp_eq_u32 s94, 0
    s_cbranch_scc1 L_wt
    ds_read_b64_tr_b16 v[120:121], v197 offset:0
    ds_read_b64_tr_b16 v[122:123], v197 offset:512
    ds_read_b64_tr_b16 v[124:125], v198 offset:0
    ds_read_b64_tr_b16 v[126:127], v198 offset:512
    ds_read_b64_tr_b16 v[128:129], v199 offset:0
    ds_read_b64_tr_b16 v[130:131], v199 offset:512
    ds_read_b64_tr_b16 v[132:133], v200 offset:0
    ds_read_b64_tr_b16 v[134:135], v200 offset:512
    ds_read_b64_tr_b16 v[136:137], v197 offset:4096
    ds_read_b64_tr_b16 v[138:139], v197 offset:4608
    ds_read_b64_tr_b16 v[140:141], v198 offset:4096
    ds_read_b64_tr_b16 v[142:143], v198 offset:4608
    ds_read_b64_tr_b16 v[144:145], v199 offset:4096
    ds_read_b64_tr_b16 v[146:147], v199 offset:4608
    ds_read_b64_tr_b16 v[148:149], v200 offset:4096
    ds_read_b64_tr_b16 v[150:151], v200 offset:4608
L_wt:
    s_waitcnt vmcnt(0)
    v_cmp_ne_u32 vcc, s30, v59
    v_cmp_ne_u32 s[96:97], s30, v63
    s_or_b64 vcc, vcc, s[96:97]
    s_cbranch_vccz L_p1_done
    s_sub_u32 s31, s31, 1
    s_cbranch_scc0 L_p1
L_p1_done:
    v_max_f32 v82, v58, v62
    v_lshlrev_b32 v64, 16, v56
    v_and_b32 v65, 0xffff0000, v56
    v_max_f32_dpp v82, v82, v82 row_ror:4 row_mask:0xf bank_mask:0xf
    v_lshlrev_b32 v66, 16, v57
    v_and_b32 v67, 0xffff0000, v57
    v_max_f32_dpp v82, v82, v82 row_ror:8 row_mask:0xf bank_mask:0xf
    v_mov_b32 v83, v82
    v_lshlrev_b32 v68, 16, v60
    v_and_b32 v69, 0xffff0000, v60
    v_permlane16_swap_b32 v83, v82
    v_max_f32 v82, v83, v82
    v_mov_b32 v83, v82
    v_lshlrev_b32 v70, 16, v61
    v_and_b32 v71, 0xffff0000, v61
    v_permlane32_swap_b32 v83, v82
    v_max_f32 v82, v83, v82
    v_sub_f32 v58, v58, v82
    v_sub_f32 v62, v62, v82
    v_exp_f32 v58, v58
    v_exp_f32 v62, v62
    s_nop 0
    v_mul_f32 v64, v58, v64
    v_mul_f32 v65, v58, v65
    v_mul_f32 v66, v58, v66
    v_mul_f32 v67, v58, v67
    v_add_f32 v56, v58, v62
    v_fmac_f32 v64, v62, v68
    v_fmac_f32 v65, v62, v69
    v_fmac_f32 v66, v62, v70
    v_fmac_f32 v67, v62, v71
    v_mov_b32 v57, v56
    s_nop 0
    v_permlane32_swap_b32 v64, v66
    v_permlane32_swap_b32 v65, v67
    v_permlane32_swap_b32 v57, v56
    v_add_f32 v64, v64, v66
    v_add_f32 v65, v65, v67
    v_add_f32 v56, v57, v56
    v_mov_b32 v57, v56
    s_nop 0
    v_permlane16_swap_b32 v64, v65
    v_permlane16_swap_b32 v57, v56
    v_add_f32 v64, v64, v65
    v_add_f32 v56, v57, v56
    s_nop 0
    v_add_f32_dpp v64, v64, v64 row_ror:4 row_mask:0xf bank_mask:0xf
    v_add_f32_dpp v56, v56, v56 row_ror:4 row_mask:0xf bank_mask:0xf
    s_nop 0
    v_add_f32_dpp v64, v64, v64 row_ror:8 row_mask:0xf bank_mask:0xf
    v_add_f32_dpp v56, v56, v56 row_ror:8 row_mask:0xf bank_mask:0xf
    v_rcp_f32 v56, v56
    s_cmp_eq_u32 s24, 4
    s_mov_b32 exec_lo, 0x000f000f
    s_mov_b32 exec_hi, 0x000f000f
    v_mul_f32 v64, v56, v64
    v_cvt_pk_bf16_f32 v64, v64, v64
    ds_write_b16 v190, v64
    s_mov_b64 exec, -1
    v_mov_b32 v50, 0
    s_mov_b64 exec, 1
    ds_add_u32 v207, v208 offset:20
    s_mov_b64 exec, -1
    s_cmp_lg_u32 s94, 0
    s_cbranch_scc1 L_wh
    s_mov_b32 s31, 0x400000
    ds_read_b32 v209, v207 offset:36
    s_waitcnt lgkmcnt(0)
    v_readfirstlane_b32 s3, v209
    s_cmp_ge_u32 s3, 1
    s_cbranch_scc1 L_ww_ok
L_ww:
    ds_read_b32 v209, v207 offset:36
    s_sub_u32 s31, s31, 1
    s_cselect_b32 s7, 0x7fffffff, 0
    s_waitcnt lgkmcnt(0)
    v_readfirstlane_b32 s3, v209
    s_or_b32 s3, s3, s7
    s_cmp_ge_u32 s3, 1
    s_cbranch_scc0 L_ww
L_ww_ok:
    ds_read_b64_tr_b16 v[120:121], v197 offset:0
    ds_read_b64_tr_b16 v[122:123], v197 offset:512
    ds_read_b64_tr_b16 v[124:125], v198 offset:0
    ds_read_b64_tr_b16 v[126:127], v198 offset:512
    ds_read_b64_tr_b16 v[128:129], v199 offset:0
    ds_read_b64_tr_b16 v[130:131], v199 offset:512
    ds_read_b64_tr_b16 v[132:133], v200 offset:0
    ds_read_b64_tr_b16 v[134:135], v200 offset:512
    ds_read_b64_tr_b16 v[136:137], v197 offset:4096
    ds_read_b64_tr_b16 v[138:139], v197 offset:4608
    ds_read_b64_tr_b16 v[140:141], v198 offset:4096
    ds_read_b64_tr_b16 v[142:143], v198 offset:4608
    ds_read_b64_tr_b16 v[144:145], v199 offset:4096
    ds_read_b64_tr_b16 v[146:147], v199 offset:4608
    ds_read_b64_tr_b16 v[148:149], v200 offset:4096
    ds_read_b64_tr_b16 v[150:151], v200 offset:4608
L_wh:
    s_mov_b32 s31, 0x400000
    ds_read_b32 v209, v207 offset:20
    ds_read_b128 v[64:67], v191
    ds_read_b128 v[68:71], v191 offset:64
    s_waitcnt lgkmcnt(2)
    v_readfirstlane_b32 s3, v209
    s_cmp_ge_u32 s3, 4
    s_cbranch_scc1 L_b3_ok
L_b3:
    ds_read_b32 v209, v207 offset:20
    s_sub_u32 s31, s31, 1
    s_cselect_b32 s7, 0x7fffffff, 0
    s_waitcnt lgkmcnt(0)
    v_readfirstlane_b32 s3, v209
    s_or_b32 s3, s3, s7
    s_cmp_ge_u32 s3, 4
    s_cbranch_scc0 L_b3
    ds_read_b128 v[64:67], v191
    ds_read_b128 v[68:71], v191 offset:64
L_b3_ok:
    s_waitcnt lgkmcnt(1)
    v_mfma_f32_16x16x32_bf16 v[88:91], v[64:67], v[120:123], 0
    v_mfma_f32_16x16x32_bf16 v[92:95], v[64:67], v[124:127], 0
    v_mfma_f32_16x16x32_bf16 v[96:99], v[64:67], v[128:131], 0
    v_mfma_f32_16x16x32_bf16 v[100:103], v[64:67], v[132:135], 0
    s_waitcnt lgkmcnt(0)
    v_mfma_f32_16x16x32_bf16 v[88:91], v[68:71], v[136:139], v[88:91]
    v_mfma_f32_16x16x32_bf16 v[92:95], v[68:71], v[140:143], v[92:95]
    v_mfma_f32_16x16x32_bf16 v[96:99], v[68:71], v[144:147], v[96:99]
    v_mfma_f32_16x16x32_bf16 v[100:103], v[68:71], v[148:151], v[100:103]
    s_nop 5
    v_mov_b32_dpp v88, v92 quad_perm:[0,1,2,3] row_mask:0x2 bank_mask:0xf
    v_mov_b32_dpp v88, v96 quad_perm:[0,1,2,3] row_mask:0x4 bank_mask:0xf
    v_mov_b32_dpp v88, v100 quad_perm:[0,1,2,3] row_mask:0x8 bank_mask:0xf
    v_bfi_b32 v48, 15, v201, v88
    buffer_store_dword v48, v192, s[20:23], 0 offen sc1
    s_and_b32 s3, s24, 3
    s_cbranch_scc1 L_fin
    s_cmp_ge_u32 s93, 64
    s_cbranch_scc1 L_fin
    ds_read_b32 v209, v207 offset:28
    ds_read_b32 v4, v194
    ds_read_b32 v6, v194 offset:128
    s_mov_b32 s31, 0x40000
    s_movk_i32 s4, 0x1000
    s_waitcnt vmcnt(0)
L_p2:
    buffer_load_dwordx4 v[88:91], v193, s[20:23], 0 offen offset:0 sc1
    buffer_load_dwordx4 v[92:95], v193, s[20:23], 0 offen offset:1024 sc1
    buffer_load_dwordx4 v[96:99], v193, s[20:23], 0 offen offset:2048 sc1
    buffer_load_dwordx4 v[100:103], v193, s[20:23], 0 offen offset:3072 sc1
    buffer_load_dwordx4 v[104:107], v193, s[20:23], s4 offen offset:0 sc1
    buffer_load_dwordx4 v[108:111], v193, s[20:23], s4 offen offset:1024 sc1
    buffer_load_dwordx4 v[112:115], v193, s[20:23], s4 offen offset:2048 sc1
    buffer_load_dwordx4 v[116:119], v193, s[20:23], s4 offen offset:3072 sc1
    s_waitcnt vmcnt(7)
    v_xor_b32 v88, v203, v88
    v_xor_b32 v89, v204, v89
    v_xor_b32 v90, v205, v90
    v_xor_b32 v91, v206, v91
    v_or_b32 v82, v88, v89
    v_or3_b32 v82, v90, v91, v82
    s_waitcnt vmcnt(6)
    v_xor_b32 v92, v203, v92
    v_xor_b32 v93, v204, v93
    v_xor_b32 v94, v205, v94
    v_xor_b32 v95, v206, v95
    v_or3_b32 v82, v92, v93, v82
    v_or3_b32 v82, v94, v95, v82
    v_pk_add_f32 v[56:57], v[88:89], v[92:93]
    v_pk_add_f32 v[58:59], v[90:91], v[94:95]
    s_waitcnt vmcnt(5)
    v_xor_b32 v96, v203, v96
    v_xor_b32 v97, v204, v97
    v_xor_b32 v98, v205, v98
    v_xor_b32 v99, v206, v99
    v_or3_b32 v82, v96, v97, v82
    v_or3_b32 v82, v98, v99, v82
    v_pk_add_f32 v[56:57], v[56:57], v[96:97]
    v_pk_add_f32 v[58:59], v[58:59], v[98:99]
    s_waitcnt vmcnt(4)
    v_xor_b32 v100, v203, v100
    v_xor_b32 v101, v204, v101
    v_xor_b32 v102, v205, v102
    v_xor_b32 v103, v206, v103
    v_or3_b32 v82, v100, v101, v82
    v_or3_b32 v82, v102, v103, v82
    v_pk_add_f32 v[56:57], v[56:57], v[100:101]
    v_pk_add_f32 v[58:59], v[58:59], v[102:103]
    s_waitcnt vmcnt(3)
    v_xor_b32 v104, v203, v104
    v_xor_b32 v105, v204, v105
    v_xor_b32 v106, v205, v106
    v_xor_b32 v107, v206, v107
    v_or3_b32 v82, v104, v105, v82
    v_or3_b32 v82, v106, v107, v82
    v_pk_add_f32 v[56:57], v[56:57], v[104:105]
    v_pk_add_f32 v[58:59], v[58:59], v[106:107]
    s_waitcnt vmcnt(2)
    v_xor_b32 v108, v203, v108
    v_xor_b32 v109, v204, v109
    v_xor_b32 v110, v205, v110
    v_xor_b32 v111, v206, v111
    v_or3_b32 v82, v108, v109, v82
    v_or3_b32 v82, v110, v111, v82
    v_pk_add_f32 v[56:57], v[56:57], v[108:109]
    v_pk_add_f32 v[58:59], v[58:59], v[110:111]
    s_waitcnt vmcnt(1)
    v_xor_b32 v112, v203, v112
    v_xor_b32 v113, v204, v113
    v_xor_b32 v114, v205, v114
    v_xor_b32 v115, v206, v115
    v_or3_b32 v82, v112, v113, v82
    v_or3_b32 v82, v114, v115, v82
    v_pk_add_f32 v[56:57], v[56:57], v[112:113]
    v_pk_add_f32 v[58:59], v[58:59], v[114:115]
    s_waitcnt vmcnt(0)
    v_xor_b32 v116, v203, v116
    v_xor_b32 v117, v204, v117
    v_xor_b32 v118, v205, v118
    v_xor_b32 v119, v206, v119
    v_or3_b32 v82, v116, v117, v82
    v_or3_b32 v82, v118, v119, v82
    v_pk_add_f32 v[56:57], v[56:57], v[116:117]
    v_pk_add_f32 v[58:59], v[58:59], v[118:119]
    v_and_b32 v82, 15, v82
    v_cmp_ne_u32 vcc, 0, v82
    s_cbranch_vccz L_p2_done
    s_sub_u32 s31, s31, 1
    s_cbranch_scc0 L_p2
L_p2_done:
    s_nop 1
    v_permlane32_swap_b32 v56, v58
    v_permlane32_swap_b32 v57, v59
    v_add_f32 v56, v56, v58
    v_add_f32 v57, v57, v59
    s_nop 1
    v_permlane16_swap_b32 v56, v57
    v_add_f32 v56, v56, v57
    s_nop 1
    v_add_f32_dpp v56, v56, v56 row_ror:8 row_mask:0xf bank_mask:0xf
    s_waitcnt lgkmcnt(0)
    v_readfirstlane_b32 s3, v209
    s_cmp_lg_u32 s3, 0
    s_cbranch_scc1 L_gok
    s_mov_b32 s31, 0x400000
    ds_read_b32 v209, v207 offset:28
    ds_read_b32 v4, v194
    ds_read_b32 v6, v194 offset:128
    s_waitcnt lgkmcnt(2)
    v_readfirstlane_b32 s3, v209
    s_cmp_ge_u32 s3, 1
    s_cbranch_scc1 L_g_ok
L_g:
    ds_read_b32 v209, v207 offset:28
    s_sub_u32 s31, s31, 1
    s_cselect_b32 s7, 0x7fffffff, 0
    s_waitcnt lgkmcnt(0)
    v_readfirstlane_b32 s3, v209
    s_or_b32 s3, s3, s7
    s_cmp_ge_u32 s3, 1
    s_cbranch_scc0 L_g
    ds_read_b32 v4, v194
    ds_read_b32 v6, v194 offset:128
L_g_ok:
    s_waitcnt lgkmcnt(0)
L_gok:
    v_cvt_pk_bf16_f32 v82, v56, v56
    v_lshlrev_b32 v56, 16, v82
    v_mul_f32 v56, v56, v4
    v_cvt_pk_bf16_f32 v82, v56, v56
    v_lshlrev_b32 v56, 16, v82
    v_add_f32 v56, v56, v6
    v_cvt_pk_bf16_f32 v56, v56, v56
    s_mov_b32 exec_lo, 0xff00ff
    s_mov_b32 exec_hi, 0xff00ff
    buffer_store_short v56, v195, s[16:19], 0 offen
    s_mov_b64 exec, -1
L_fin:
    s_waitcnt vmcnt(0)
    s_endpgm
L_slow:
    s_mov_b32 s31, 0x400000
    ds_read_b32 v209, v207 offset:16
    ds_read_b128 v[24:27], v219 offset:0
    ds_read_b128 v[28:31], v219 offset:1024
    ds_read_b128 v[32:35], v220 offset:0
    ds_read_b128 v[36:39], v220 offset:1024
    ds_read_b128 v[40:43], v221 offset:0
    ds_read_b128 v[44:47], v221 offset:1024
    s_waitcnt lgkmcnt(6)
    v_readfirstlane_b32 s3, v209
    s_cmp_ge_u32 s3, 3
    s_cbranch_scc1 L_sl_ok
L_sl:
    ds_read_b32 v209, v207 offset:16
    s_sub_u32 s31, s31, 1
    s_cselect_b32 s7, 0x7fffffff, 0
    s_waitcnt lgkmcnt(0)
    v_readfirstlane_b32 s3, v209
    s_or_b32 s3, s3, s7
    s_cmp_ge_u32 s3, 3
    s_cbranch_scc0 L_sl
    ds_read_b128 v[24:27], v219 offset:0
    ds_read_b128 v[28:31], v219 offset:1024
    ds_read_b128 v[32:35], v220 offset:0
    ds_read_b128 v[36:39], v220 offset:1024
    ds_read_b128 v[40:43], v221 offset:0
    ds_read_b128 v[44:47], v221 offset:1024
L_sl_ok:
    s_branch L_add
L_dep:
    ds_write_b128 v184, v[210:213] offset:0
    ds_write_b128 v184, v[214:217] offset:1024
    s_mov_b64 exec, 1
    ds_add_u32 v207, v208 offset:16
    s_mov_b64 exec, -1
    s_cmp_ge_u32 s26, 16
    s_waitcnt lgkmcnt(0)
    s_cbranch_scc1 L_fin
    s_mov_b32 s31, 0x400000
    ds_read_b32 v209, v207 offset:16
    s_waitcnt lgkmcnt(0)
    v_readfirstlane_b32 s3, v209
    s_cmp_ge_u32 s3, 4
    s_cbranch_scc1 L_dw_ok
L_dw:
    ds_read_b32 v209, v207 offset:16
    s_sub_u32 s31, s31, 1
    s_cselect_b32 s7, 0x7fffffff, 0
    s_waitcnt lgkmcnt(0)
    v_readfirstlane_b32 s3, v209
    s_or_b32 s3, s3, s7
    s_cmp_ge_u32 s3, 4
    s_cbranch_scc0 L_dw
L_dw_ok:
    s_branch L_hop
L_aux:
    s_setprio 3
    v_lshlrev_b32 v3, 4, v0
    s_and_b32 s3, s26, 7
    s_lshl_b32 s27, s3, 6
    s_lshr_b32 s63, s26, 3
    s_lshl_b32 s3, s25, 9
    s_add_u32 s3, s3, s27
    s_lshl_b32 s3, s3, 1
    s_lshl_b32 s7, s63, 20
    s_add_u32 s3, s3, s7
    v_lshrrev_b32 v16, 3, v0
    v_lshlrev_b32 v16, 13, v16
    v_and_b32 v17, 7, v0
    v_lshrrev_b32 v24, 3, v0
    v_and_b32 v24, 2, v24
    v_xor_b32 v17, v17, v24
    v_lshl_or_b32 v16, v17, 4, v16
    v_add_u32 v16, s3, v16
    v_xor_b32 v24, 64, v16
    v_mov_b32 v18, 150144
    v_mov_b32 v19, 0
    ds_write_b32 v18, v19 offset:4
    ds_write2_b32 v18, v19, v19 offset0:4 offset1:5
    ds_write2_b32 v18, v19, v19 offset0:6 offset1:7
    ds_write2_b32 v18, v19, v19 offset0:8 offset1:9
    ds_write_b32 v18, v19 offset:40
    s_waitcnt lgkmcnt(0)
    s_barrier
    s_mov_b32 s8, s32
    s_mov_b32 s9, s33
    s_mov_b32 s10, 0x400
    s_mov_b32 s11, 0x20000
    s_mov_b32 s12, s38
    s_mov_b32 s13, s39
    s_mov_b32 s14, 0x400000
    s_mov_b32 s15, 0x20000
    s_mov_b32 s20, s54
    s_mov_b32 s21, s55
    s_mov_b32 s22, 0x400000
    s_mov_b32 s23, 0x20000
    buffer_load_dwordx4 v[4:7], v3, s[8:11], 0 offen
    buffer_load_dword v17, off, s[20:23], 0 offset:0 sc1
    s_mov_b32 s4, 0
    s_mov_b32 m0, 131072
    s_nop 0
    buffer_load_dwordx4 v16, s[12:15], s4 offen nt lds
    s_mov_b32 m0, 132096
    s_add_u32 s4, s4, 65536
    buffer_load_dwordx4 v24, s[12:15], s4 offen nt lds
    s_mov_b32 m0, 133120
    s_add_u32 s4, s4, 65536
    buffer_load_dwordx4 v16, s[12:15], s4 offen nt lds
    s_mov_b32 m0, 134144
    s_add_u32 s4, s4, 65536
    buffer_load_dwordx4 v24, s[12:15], s4 offen nt lds
    s_mov_b32 m0, 135168
    s_add_u32 s4, s4, 65536
    buffer_load_dwordx4 v16, s[12:15], s4 offen nt lds
    s_mov_b32 m0, 136192
    s_add_u32 s4, s4, 65536
    buffer_load_dwordx4 v24, s[12:15], s4 offen nt lds
    s_mov_b32 m0, 137216
    s_add_u32 s4, s4, 65536
    buffer_load_dwordx4 v16, s[12:15], s4 offen nt lds
    s_mov_b32 m0, 138240
    s_add_u32 s4, s4, 65536
    buffer_load_dwordx4 v24, s[12:15], s4 offen nt lds
    s_mov_b32 m0, 139264
    s_add_u32 s4, s4, 65536
    buffer_load_dwordx4 v16, s[12:15], s4 offen nt lds
    s_mov_b32 m0, 140288
    s_add_u32 s4, s4, 65536
    buffer_load_dwordx4 v24, s[12:15], s4 offen nt lds
    s_mov_b32 m0, 141312
    s_add_u32 s4, s4, 65536
    buffer_load_dwordx4 v16, s[12:15], s4 offen nt lds
    s_mov_b32 m0, 142336
    s_add_u32 s4, s4, 65536
    buffer_load_dwordx4 v24, s[12:15], s4 offen nt lds
    s_mov_b32 m0, 143360
    s_add_u32 s4, s4, 65536
    buffer_load_dwordx4 v16, s[12:15], s4 offen nt lds
    s_mov_b32 m0, 144384
    s_add_u32 s4, s4, 65536
    buffer_load_dwordx4 v24, s[12:15], s4 offen nt lds
    s_mov_b32 m0, 145408
    s_add_u32 s4, s4, 65536
    buffer_load_dwordx4 v16, s[12:15], s4 offen nt lds
    s_mov_b32 m0, 146432
    s_add_u32 s4, s4, 65536
    buffer_load_dwordx4 v24, s[12:15], s4 offen nt lds
    v_and_b32 v18, 15, v0
    s_lshl_b32 s3, s93, 6
    v_lshl_add_u32 v18, v18, 2, s3
    buffer_load_dword v18, v18, s[8:11], 0 offen
    s_mul_i32 s3, s25, 16384
    s_add_u32 s3, s3, 32768
    v_mul_u32_u24 v19, 4096, v0
    v_add_u32 v19, s3, v19
    v_mov_b32 v20, 0
    s_cmp_eq_u32 s26, 0
    s_cselect_b32 vcc_lo, 15, 0
    s_mov_b32 vcc_hi, 0
    v_mov_b32 v21, 0x7ffffff0
    v_cndmask_b32 v19, v21, v19, vcc
    buffer_store_dword v20, v19, s[20:23], 0 offen sc1
    s_waitcnt vmcnt(18)
    v_readfirstlane_b32 s30, v17
    v_lshlrev_b32 v8, 16, v4
    v_and_b32 v9, 0xffff0000, v4
    v_lshlrev_b32 v10, 16, v5
    v_and_b32 v11, 0xffff0000, v5
    v_lshlrev_b32 v12, 16, v6
    v_and_b32 v13, 0xffff0000, v6
    v_lshlrev_b32 v14, 16, v7
    v_and_b32 v15, 0xffff0000, v7
    s_mul_i32 s30, s30, 0x9e3779b1
    s_add_u32 s30, s30, 0x7f4a7c15
    v_add_f32 v21, v8, v9
    v_add_f32 v21, v21, v10
    v_add_f32 v21, v21, v11
    v_add_f32 v21, v21, v12
    v_add_f32 v21, v21, v13
    v_add_f32 v21, v21, v14
    v_add_f32 v21, v21, v15
    s_nop 1
    v_add_f32_dpp v21, v21, v21 quad_perm:[1,0,3,2] row_mask:0xf bank_mask:0xf
    s_nop 1
    v_add_f32_dpp v21, v21, v21 quad_perm:[2,3,0,1] row_mask:0xf bank_mask:0xf
    s_nop 1
    v_add_f32_dpp v21, v21, v21 row_half_mirror row_mask:0xf bank_mask:0xf
    s_nop 1
    v_add_f32_dpp v21, v21, v21 row_mirror row_mask:0xf bank_mask:0xf
    v_mov_b32 v22, v21
    s_nop 1
    v_permlane16_swap_b32 v22, v21
    v_add_f32 v21, v22, v21
    v_mov_b32 v22, v21
    s_nop 1
    v_permlane32_swap_b32 v22, v21
    v_add_f32 v21, v22, v21
    v_mul_f32 v21, 0x3b000000, v21
    v_sub_f32 v23, v8, v21
    v_mul_f32 v22, v23, v23
    v_sub_f32 v23, v9, v21
    v_fmac_f32 v22, v23, v23
    v_sub_f32 v23, v10, v21
    v_fmac_f32 v22, v23, v23
    v_sub_f32 v23, v11, v21
    v_fmac_f32 v22, v23, v23
    v_sub_f32 v23, v12, v21
    v_fmac_f32 v22, v23, v23
    v_sub_f32 v23, v13, v21
    v_fmac_f32 v22, v23, v23
    v_sub_f32 v23, v14, v21
    v_fmac_f32 v22, v23, v23
    v_sub_f32 v23, v15, v21
    v_fmac_f32 v22, v23, v23
    s_nop 1
    v_add_f32_dpp v22, v22, v22 quad_perm:[1,0,3,2] row_mask:0xf bank_mask:0xf
    s_nop 1
    v_add_f32_dpp v22, v22, v22 quad_perm:[2,3,0,1] row_mask:0xf bank_mask:0xf
    s_nop 1
    v_add_f32_dpp v22, v22, v22 row_half_mirror row_mask:0xf bank_mask:0xf
    s_nop 1
    v_add_f32_dpp v22, v22, v22 row_mirror row_mask:0xf bank_mask:0xf
    v_mov_b32 v23, v22
    s_nop 1
    v_permlane16_swap_b32 v23, v22
    v_add_f32 v22, v23, v22
    v_mov_b32 v23, v22
    s_nop 1
    v_permlane32_swap_b32 v23, v22
    v_add_f32 v22, v23, v22
    v_mul_f32 v22, 0x3b000000, v22
    v_cvt_pk_bf16_f32 v23, v21, v22
    v_lshlrev_b32 v21, 16, v23
    v_and_b32 v22, 0xffff0000, v23
    v_add_f32 v22, 0x3727c5ac, v22
    v_cvt_pk_bf16_f32 v23, v22, v22
    v_lshlrev_b32 v22, 16, v23
    v_sqrt_f32 v22, v22
    v_sub_f32 v8, v8, v21
    v_sub_f32 v9, v9, v21
    v_sub_f32 v10, v10, v21
    v_sub_f32 v11, v11, v21
    v_sub_f32 v12, v12, v21
    v_sub_f32 v13, v13, v21
    v_sub_f32 v14, v14, v21
    v_sub_f32 v15, v15, v21
    v_cvt_pk_bf16_f32 v23, v22, v22
    v_lshlrev_b32 v22, 16, v23
    v_rcp_f32 v21, v22
    v_cvt_pk_bf16_f32 v23, v8, v9
    v_lshlrev_b32 v8, 16, v23
    v_and_b32 v9, 0xffff0000, v23
    v_cvt_pk_bf16_f32 v23, v10, v11
    v_lshlrev_b32 v10, 16, v23
    v_and_b32 v11, 0xffff0000, v23
    v_cvt_pk_bf16_f32 v23, v12, v13
    v_lshlrev_b32 v12, 16, v23
    v_and_b32 v13, 0xffff0000, v23
    v_cvt_pk_bf16_f32 v23, v14, v15
    v_lshlrev_b32 v14, 16, v23
    v_and_b32 v15, 0xffff0000, v23
    v_mul_f32 v23, v8, v21
    v_fma_f32 v8, -v23, v22, v8
    v_fma_f32 v8, v8, v21, v23
    v_mul_f32 v23, v9, v21
    v_fma_f32 v9, -v23, v22, v9
    v_fma_f32 v9, v9, v21, v23
    v_mul_f32 v23, v10, v21
    v_fma_f32 v10, -v23, v22, v10
    v_fma_f32 v10, v10, v21, v23
    v_mul_f32 v23, v11, v21
    v_fma_f32 v11, -v23, v22, v11
    v_fma_f32 v11, v11, v21, v23
    v_mul_f32 v23, v12, v21
    v_fma_f32 v12, -v23, v22, v12
    v_fma_f32 v12, v12, v21, v23
    v_mul_f32 v23, v13, v21
    v_fma_f32 v13, -v23, v22, v13
    v_fma_f32 v13, v13, v21, v23
    v_mul_f32 v23, v14, v21
    v_fma_f32 v14, -v23, v22, v14
    v_fma_f32 v14, v14, v21, v23
    v_mul_f32 v23, v15, v21
    v_fma_f32 v15, -v23, v22, v15
    v_fma_f32 v15, v15, v21, v23
    v_cvt_pk_bf16_f32 v4, v8, v9
    v_cvt_pk_bf16_f32 v5, v10, v11
    v_cvt_pk_bf16_f32 v6, v12, v13
    v_cvt_pk_bf16_f32 v7, v14, v15
    v_add_u32 v21, 147456, v3
    ds_write_b128 v21, v[4:7]
    s_mov_b32 s60, 0
    s_sub_u32 s61, s26, 22
    s_cmp_lt_u32 s61, 7
    s_cselect_b32 s60, 2, 0
    s_sub_u32 s3, s26, 8
    s_cmp_lt_u32 s3, 14
    s_cbranch_scc0 L_nra
    s_mul_i32 s7, s25, 14
    s_add_u32 s3, s3, s7
    s_mov_b32 s60, 1
    s_lshr_b32 s61, s3, 2
    s_and_b32 s62, s3, 3
L_nra:
    s_lshl_b32 s3, s63, 8
    s_add_u32 s3, s3, 147456
    v_lshl_add_u32 v24, v1, 4, s3
    v_lshrrev_b32 v21, 2, v2
    v_lshl_add_u32 v23, v1, 3, v21
    v_and_b32 v22, 3, v0
    v_lshlrev_b32 v25, 7, v23
    v_lshl_or_b32 v25, v22, 3, v25
    v_and_b32 v22, 1, v1
    v_lshrrev_b32 v21, 1, v21
    v_lshl_or_b32 v22, v22, 1, v21
    v_lshl_or_b32 v25, v22, 5, v25
    v_add_u32 v25, 131072, v25
    v_xor_b32 v26, 32, v25
    v_xor_b32 v27, 64, v25
    v_xor_b32 v28, 96, v25
    s_waitcnt lgkmcnt(0)
    ds_read_b128 v[48:51], v24 offset:0
    ds_read_b128 v[52:55], v24 offset:64
    ds_read_b128 v[56:59], v24 offset:128
    ds_read_b128 v[60:63], v24 offset:192
    s_mul_i32 s4, s25, 8192
    s_add_u32 s4, s4, 196608
    s_lshl_b32 s3, s63, 11
    s_add_u32 s3, s3, s4
    s_lshl_b32 s7, s27, 2
    s_add_u32 s3, s3, s7
    v_cmp_eq_u32 s[34:35], 1, v2
    v_cmp_eq_u32 s[36:37], 2, v2
    v_cmp_eq_u32 s[42:43], 3, v2
    v_lshlrev_b32 v21, 6, v1
    v_lshl_or_b32 v21, v2, 4, v21
    s_mul_i32 s59, s30, 0x85ebca6b
    s_xor_b32 s59, s59, 0x5a5aa5a5
    s_mov_b32 s56, -16
    v_and_b32 v82, 2, v0
    v_and_b32 v81, 1, v0
    v_cmp_eq_u32 vcc, 2, v82
    v_mov_b32 v23, s30
    v_mov_b32 v22, s59
    v_lshlrev_b32 v81, 4, v81
    v_cndmask_b32 v80, v23, v22, vcc
    v_lshrrev_b32 v80, v81, v80
    v_bfe_u32 v83, v80, 12, 4
    v_bfe_u32 v82, v80, 8, 4
    v_bfe_u32 v81, v80, 4, 4
    v_bfe_u32 v80, v80, 0, 4
    s_waitcnt vmcnt(0) lgkmcnt(0)
    ds_read_b64_tr_b16 v[96:97], v25 offset:0
    ds_read_b64_tr_b16 v[98:99], v25 offset:512
    ds_read_b64_tr_b16 v[100:101], v26 offset:0
    ds_read_b64_tr_b16 v[102:103], v26 offset:512
    ds_read_b64_tr_b16 v[104:105], v27 offset:0
    ds_read_b64_tr_b16 v[106:107], v27 offset:512
    ds_read_b64_tr_b16 v[108:109], v28 offset:0
    ds_read_b64_tr_b16 v[110:111], v28 offset:512
    ds_read_b64_tr_b16 v[112:113], v25 offset:4096
    ds_read_b64_tr_b16 v[114:115], v25 offset:4608
    ds_read_b64_tr_b16 v[116:117], v26 offset:4096
    ds_read_b64_tr_b16 v[118:119], v26 offset:4608
    ds_read_b64_tr_b16 v[120:121], v27 offset:4096
    ds_read_b64_tr_b16 v[122:123], v27 offset:4608
    s_waitcnt lgkmcnt(12)
    v_mfma_f32_16x16x32_bf16 v[32:35], v[96:99], v[48:51], 0
    ds_read_b64_tr_b16 v[124:125], v28 offset:4096
    ds_read_b64_tr_b16 v[126:127], v28 offset:4608
    s_waitcnt lgkmcnt(12)
    v_mfma_f32_16x16x32_bf16 v[36:39], v[100:103], v[48:51], 0
    ds_read_b64_tr_b16 v[128:129], v25 offset:8192
    ds_read_b64_tr_b16 v[130:131], v25 offset:8704
    s_waitcnt lgkmcnt(12)
    v_mfma_f32_16x16x32_bf16 v[40:43], v[104:107], v[48:51], 0
    ds_read_b64_tr_b16 v[132:133], v26 offset:8192
    ds_read_b64_tr_b16 v[134:135], v26 offset:8704
    s_waitcnt lgkmcnt(12)
    v_mfma_f32_16x16x32_bf16 v[44:47], v[108:111], v[48:51], 0
    ds_read_b64_tr_b16 v[136:137], v27 offset:8192
    ds_read_b64_tr_b16 v[138:139], v27 offset:8704
    s_waitcnt lgkmcnt(12)
    v_mfma_f32_16x16x32_bf16 v[32:35], v[112:115], v[52:55], v[32:35]
    ds_read_b64_tr_b16 v[140:141], v28 offset:8192
    ds_read_b64_tr_b16 v[142:143], v28 offset:8704
    s_waitcnt lgkmcnt(12)
    v_mfma_f32_16x16x32_bf16 v[36:39], v[116:119], v[52:55], v[36:39]
    ds_read_b64_tr_b16 v[144:145], v25 offset:12288
    ds_read_b64_tr_b16 v[146:147], v25 offset:12800
    s_waitcnt lgkmcnt(12)
    v_mfma_f32_16x16x32_bf16 v[40:43], v[120:123], v[52:55], v[40:43]
    ds_read_b64_tr_b16 v[148:149], v26 offset:12288
    ds_read_b64_tr_b16 v[150:151], v26 offset:12800
    s_waitcnt lgkmcnt(12)
    v_mfma_f32_16x16x32_bf16 v[44:47], v[124:127], v[52:55], v[44:47]
    ds_read_b64_tr_b16 v[152:153], v27 offset:12288
    ds_read_b64_tr_b16 v[154:155], v27 offset:12800
    s_waitcnt lgkmcnt(12)
    v_mfma_f32_16x16x32_bf16 v[32:35], v[128:131], v[56:59], v[32:35]
    ds_read_b64_tr_b16 v[156:157], v28 offset:12288
    ds_read_b64_tr_b16 v[158:159], v28 offset:12800
    s_waitcnt lgkmcnt(12)
    v_mfma_f32_16x16x32_bf16 v[36:39], v[132:135], v[56:59], v[36:39]
    s_waitcnt lgkmcnt(10)
    v_mfma_f32_16x16x32_bf16 v[40:43], v[136:139], v[56:59], v[40:43]
    s_waitcnt lgkmcnt(8)
    v_mfma_f32_16x16x32_bf16 v[44:47], v[140:143], v[56:59], v[44:47]
    s_waitcnt lgkmcnt(6)
    v_mfma_f32_16x16x32_bf16 v[32:35], v[144:147], v[60:63], v[32:35]
    s_waitcnt lgkmcnt(4)
    v_mfma_f32_16x16x32_bf16 v[36:39], v[148:151], v[60:63], v[36:39]
    s_waitcnt lgkmcnt(2)
    v_mfma_f32_16x16x32_bf16 v[40:43], v[152:155], v[60:63], v[40:43]
    s_waitcnt lgkmcnt(0)
    v_mfma_f32_16x16x32_bf16 v[44:47], v[156:159], v[60:63], v[44:47]
    s_nop 4
    v_cndmask_b32 v32, v32, v36, s[34:35]
    v_cndmask_b32 v33, v33, v37, s[34:35]
    v_cndmask_b32 v34, v34, v38, s[34:35]
    v_cndmask_b32 v35, v35, v39, s[34:35]
    v_cndmask_b32 v32, v32, v40, s[36:37]
    v_cndmask_b32 v33, v33, v41, s[36:37]
    v_cndmask_b32 v34, v34, v42, s[36:37]
    v_cndmask_b32 v35, v35, v43, s[36:37]
    v_cndmask_b32 v32, v32, v44, s[42:43]
    v_cndmask_b32 v33, v33, v45, s[42:43]
    v_cndmask_b32 v34, v34, v46, s[42:43]
    v_cndmask_b32 v35, v35, v47, s[42:43]
    v_add_u32 v32, 8, v32
    v_add_u32 v33, 8, v33
    v_add_u32 v34, 8, v34
    v_add_u32 v35, 8, v35
    v_and_or_b32 v32, v32, s56, v80
    v_and_or_b32 v33, v33, s56, v81
    v_and_or_b32 v34, v34, s56, v82
    v_and_or_b32 v35, v35, s56, v83
    s_mov_b32 exec_lo, 0xf000f
    s_mov_b32 exec_hi, 0xf000f
    buffer_store_dwordx4 v[32:35], v21, s[20:23], s3 offen sc1
    s_mov_b64 exec, -1
    s_add_u32 s5, s4, 4096
    v_and_b32 v22, 3, v0
    v_lshlrev_b32 v22, 5, v22
    v_lshl_or_b32 v22, v1, 7, v22
    v_bfe_u32 v21, v0, 2, 2
    v_lshl_or_b32 v21, v21, 3, v22
    v_add_u32 v21, 148480, v21
    v_mov_b32 v22, 150144
    v_mov_b32 v32, s30
    v_mov_b32 v33, 1
    s_mov_b32 s31, 0x40000
    s_waitcnt vmcnt(0)
L_pq:
    buffer_load_dwordx4 v[48:51], v3, s[20:23], s4 offen offset:0 sc1
    buffer_load_dwordx4 v[52:55], v3, s[20:23], s4 offen offset:1024 sc1
    buffer_load_dwordx4 v[56:59], v3, s[20:23], s4 offen offset:2048 sc1
    buffer_load_dwordx4 v[60:63], v3, s[20:23], s4 offen offset:3072 sc1
    buffer_load_dwordx4 v[64:67], v3, s[20:23], s5 offen offset:0 sc1
    buffer_load_dwordx4 v[68:71], v3, s[20:23], s5 offen offset:1024 sc1
    buffer_load_dwordx4 v[72:75], v3, s[20:23], s5 offen offset:2048 sc1
    buffer_load_dwordx4 v[76:79], v3, s[20:23], s5 offen offset:3072 sc1
    s_waitcnt vmcnt(7)
    v_xor_b32 v48, v80, v48
    v_xor_b32 v49, v81, v49
    v_xor_b32 v50, v82, v50
    v_xor_b32 v51, v83, v51
    v_or_b32 v23, v48, v49
    v_or3_b32 v23, v50, v51, v23
    s_waitcnt vmcnt(6)
    v_xor_b32 v52, v80, v52
    v_xor_b32 v53, v81, v53
    v_xor_b32 v54, v82, v54
    v_xor_b32 v55, v83, v55
    v_or3_b32 v23, v52, v53, v23
    v_or3_b32 v23, v54, v55, v23
    s_waitcnt vmcnt(5)
    v_xor_b32 v56, v80, v56
    v_xor_b32 v57, v81, v57
    v_xor_b32 v58, v82, v58
    v_xor_b32 v59, v83, v59
    v_or3_b32 v23, v56, v57, v23
    v_or3_b32 v23, v58, v59, v23
    s_waitcnt vmcnt(4)
    v_xor_b32 v60, v80, v60
    v_xor_b32 v61, v81, v61
    v_xor_b32 v62, v82, v62
    v_xor_b32 v63, v83, v63
    v_or3_b32 v23, v60, v61, v23
    v_or3_b32 v23, v62, v63, v23
    s_waitcnt vmcnt(3)
    v_xor_b32 v64, v80, v64
    v_xor_b32 v65, v81, v65
    v_xor_b32 v66, v82, v66
    v_xor_b32 v67, v83, v67
    v_or3_b32 v23, v64, v65, v23
    v_or3_b32 v23, v66, v67, v23
    s_waitcnt vmcnt(2)
    v_xor_b32 v68, v80, v68
    v_xor_b32 v69, v81, v69
    v_xor_b32 v70, v82, v70
    v_xor_b32 v71, v83, v71
    v_or3_b32 v23, v68, v69, v23
    v_or3_b32 v23, v70, v71, v23
    s_waitcnt vmcnt(1)
    v_xor_b32 v72, v80, v72
    v_xor_b32 v73, v81, v73
    v_xor_b32 v74, v82, v74
    v_xor_b32 v75, v83, v75
    v_or3_b32 v23, v72, v73, v23
    v_or3_b32 v23, v74, v75, v23
    s_waitcnt vmcnt(0)
    v_xor_b32 v76, v80, v76
    v_xor_b32 v77, v81, v77
    v_xor_b32 v78, v82, v78
    v_xor_b32 v79, v83, v79
    v_or3_b32 v23, v76, v77, v23
    v_or3_b32 v23, v78, v79, v23
    v_and_b32 v23, 15, v23
    v_cmp_ne_u32 vcc, 0, v23
    s_cbranch_vccz L_pq_done
    s_sleep 8
    s_sub_u32 s31, s31, 1
    s_cbranch_scc0 L_pq
L_pq_done:
    v_add_f32 v48, v48, v56
    v_add_f32 v49, v49, v57
    v_add_f32 v50, v50, v58
    v_add_f32 v51, v51, v59
    v_add_f32 v52, v52, v60
    v_add_f32 v53, v53, v61
    v_add_f32 v54, v54, v62
    v_add_f32 v55, v55, v63
    v_add_f32 v64, v64, v72
    v_add_f32 v65, v65, v73
    v_add_f32 v66, v66, v74
    v_add_f32 v67, v67, v75
    v_add_f32 v68, v68, v76
    v_add_f32 v69, v69, v77
    v_add_f32 v70, v70, v78
    v_add_f32 v71, v71, v79
    v_add_f32 v48, v48, v64
    v_add_f32 v49, v49, v65
    v_add_f32 v50, v50, v66
    v_add_f32 v51, v51, v67
    v_add_f32 v52, v52, v68
    v_add_f32 v53, v53, v69
    v_add_f32 v54, v54, v70
    v_add_f32 v55, v55, v71
    v_cvt_pk_bf16_f32 v48, v48, v49
    v_cvt_pk_bf16_f32 v49, v50, v51
    v_cvt_pk_bf16_f32 v50, v52, v53
    v_cvt_pk_bf16_f32 v51, v54, v55
    ds_write_b64 v21, v[48:49]
    ds_write_b64 v21, v[50:51] offset:512
    ds_write_b64 v22, v[32:33]
    s_setprio 0
    v_subrev_u32 v25, 131072, v25
    v_subrev_u32 v26, 131072, v26
    v_subrev_u32 v27, 131072, v27
    v_subrev_u32 v28, 131072, v28
    v_lshlrev_b32 v22, 6, v1
    v_lshl_or_b32 v22, v2, 4, v22
    s_mul_i32 s56, s25, 28
    s_max_u32 s57, s26, 4
    s_add_u32 s56, s56, s57
    s_sub_u32 s57, s56, 4
    s_bitcmp1_b32 s57, 0
    s_cselect_b32 s8, s46, s44
    s_cselect_b32 s9, s47, s45
    s_mov_b32 s10, 0x1c0000
    s_mov_b32 s11, 0x20000
    s_bfe_u32 s7, s57, 0x20001
    s_lshr_b32 s3, s57, 3
    s_mul_i32 s4, s7, 458752
    s_lshl_b32 s58, s3, 7
    s_add_u32 s4, s4, s58
    s_lshr_b32 s5, s3, 1
    s_mul_i32 s5, s5, 4224
    s_and_b32 s3, s3, 1
    s_lshl_b32 s3, s3, 8
    s_add_u32 s5, s5, s3
    s_and_b32 s3, s57, 7
    s_lshl_b32 s3, s3, 9
    s_add_u32 s5, s5, s3
    s_add_u32 s5, s5, 3145728
    s_lshl_b32 s3, s7, 8
    s_add_u32 s3, s3, 147456
    v_lshl_add_u32 v24, v1, 4, s3
    ds_read_b128 v[48:51], v24 offset:0
    ds_read_b128 v[52:55], v24 offset:64
    ds_read_b128 v[56:59], v24 offset:128
    ds_read_b128 v[60:63], v24 offset:192
    v_lshrrev_b32 v16, 3, v0
    v_and_b32 v17, 2, v16
    v_mul_u32_u24 v16, 3584, v16
    v_and_b32 v21, 7, v0
    v_xor_b32 v17, v17, v21
    v_lshl_or_b32 v16, v17, 4, v16
    v_xor_b32 v17, 64, v16
    v_lshrrev_b32 v19, 3, v0
    v_and_b32 v20, 2, v19
    v_mul_u32_u24 v19, 1024, v19
    v_and_b32 v21, 7, v0
    v_xor_b32 v20, v20, v21
    v_lshl_or_b32 v19, v20, 4, v19
    v_xor_b32 v20, 64, v19
    s_lshl_b32 s7, s28, 16
    s_add_u32 s12, s40, s7
    s_addc_u32 s13, s41, 0
    s_mov_b32 s14, 0x10000
    s_mov_b32 s15, 0x20000
    s_lshr_b32 s63, s26, 3
    s_lshl_b32 s63, s63, 9
    s_mov_b32 s16, s48
    s_mov_b32 s17, s49
    s_mov_b32 s18, 0x1c0000
    s_mov_b32 s19, 0x20000
    s_cmp_lt_u32 s26, 18
    s_cselect_b32 s18, 0, s18
    s_max_u32 s3, s26, 18
    s_sub_u32 s3, s3, 18
    s_lshl_b32 s61, s3, 17
    s_lshl_b32 s7, s25, 7
    s_add_u32 s61, s61, s7
    s_mul_i32 s56, s3, 4224
    s_add_u32 s56, s56, 3145728
    s_mul_i32 s62, s25, 4352
    s_lshl_b32 s7, s3, 7
    s_add_u32 s62, s62, s7
    s_add_u32 s62, s62, 3670016
    v_lshrrev_b32 v29, 1, v2
    v_mul_u32_u24 v29, 2176, v29
    v_and_b32 v21, 1, v0
    v_lshl_add_u32 v29, v21, 4, v29
    v_lshl_add_u32 v29, v1, 5, v29
    v_and_b32 v23, 1, v1
    v_cmp_eq_u32 vcc, 1, v23
    v_mov_b32 v84, s30
    v_mov_b32 v85, s59
    v_lshlrev_b32 v21, 4, v21
    v_cndmask_b32 v84, v84, v85, vcc
    v_lshrrev_b32 v84, v21, v84
    v_lshrrev_b32 v85, 4, v84
    v_lshrrev_b32 v86, 8, v84
    v_lshrrev_b32 v87, 12, v84
    v_lshlrev_b32 v24, 4, v1
    v_add_u32 v24, 150528, v24
    v_and_b32 v30, 3, v0
    v_lshlrev_b32 v30, 5, v30
    v_lshl_or_b32 v30, v23, 7, v30
    v_lshrrev_b32 v23, 2, v2
    v_lshl_or_b32 v30, v23, 3, v30
    v_lshrrev_b32 v23, 5, v0
    v_lshl_or_b32 v30, v23, 2, v30
    v_add_u32 v30, 150528, v30
    v_mov_b32 v21, 150144
    s_mov_b32 s31, 0x10000
    ds_read_b32 v23, v21 offset:32
    s_waitcnt lgkmcnt(0)
    v_readfirstlane_b32 s3, v23
    s_cmp_ge_u32 s3, 4
    s_cbranch_scc1 L_uw_ok
L_uw:
    s_sleep 32
    ds_read_b32 v23, v21 offset:32
    s_sub_u32 s31, s31, 1
    s_cselect_b32 s7, 0x7fffffff, 0
    s_waitcnt lgkmcnt(0)
    v_readfirstlane_b32 s3, v23
    s_or_b32 s3, s3, s7
    s_cmp_ge_u32 s3, 4
    s_cbranch_scc0 L_uw
L_uw_ok:
    s_cmp_lt_u32 s26, 16
    s_cbranch_scc1 L_vb
    s_mov_b32 s31, 0x80000
    ds_read_b32 v23, v21 offset:24
    s_waitcnt lgkmcnt(0)
    v_readfirstlane_b32 s3, v23
    s_cmp_ge_u32 s3, 2
    s_cbranch_scc1 L_taa_ok
L_taa:
    s_sleep 2
    ds_read_b32 v23, v21 offset:24
    s_sub_u32 s31, s31, 1
    s_cselect_b32 s7, 0x7fffffff, 0
    s_waitcnt lgkmcnt(0)
    v_readfirstlane_b32 s3, v23
    s_or_b32 s3, s3, s7
    s_cmp_ge_u32 s3, 2
    s_cbranch_scc0 L_taa
L_taa_ok:
    s_mov_b32 m0, 16384
    s_nop 0
    buffer_load_dwordx4 v16, s[8:11], s4 offen nt lds
    s_mov_b32 m0, 17408
    s_add_u32 s4, s4, 28672
    buffer_load_dwordx4 v17, s[8:11], s4 offen nt lds
    s_mov_b32 m0, 18432
    s_add_u32 s4, s4, 28672
    buffer_load_dwordx4 v16, s[8:11], s4 offen nt lds
    s_mov_b32 m0, 19456
    s_add_u32 s4, s4, 28672
    buffer_load_dwordx4 v17, s[8:11], s4 offen nt lds
    s_mov_b32 m0, 20480
    s_add_u32 s4, s4, 28672
    buffer_load_dwordx4 v16, s[8:11], s4 offen nt lds
    s_mov_b32 m0, 21504
    s_add_u32 s4, s4, 28672
    buffer_load_dwordx4 v17, s[8:11], s4 offen nt lds
    s_mov_b32 m0, 22528
    s_add_u32 s4, s4, 28672
    buffer_load_dwordx4 v16, s[8:11], s4 offen nt lds
    s_mov_b32 m0, 23552
    s_add_u32 s4, s4, 28672
    buffer_load_dwordx4 v17, s[8:11], s4 offen nt lds
    s_mov_b32 m0, 24576
    s_add_u32 s4, s4, 28672
    buffer_load_dwordx4 v16, s[8:11], s4 offen nt lds
    s_mov_b32 m0, 25600
    s_add_u32 s4, s4, 28672
    buffer_load_dwordx4 v17, s[8:11], s4 offen nt lds
    s_mov_b32 m0, 26624
    s_add_u32 s4, s4, 28672
    buffer_load_dwordx4 v16, s[8:11], s4 offen nt lds
    s_mov_b32 m0, 27648
    s_add_u32 s4, s4, 28672
    buffer_load_dwordx4 v17, s[8:11], s4 offen nt lds
    s_mov_b32 m0, 28672
    s_add_u32 s4, s4, 28672
    buffer_load_dwordx4 v16, s[8:11], s4 offen nt lds
    s_mov_b32 m0, 29696
    s_add_u32 s4, s4, 28672
    buffer_load_dwordx4 v17, s[8:11], s4 offen nt lds
    s_mov_b32 m0, 30720
    s_add_u32 s4, s4, 28672
    buffer_load_dwordx4 v16, s[8:11], s4 offen nt lds
    s_mov_b32 m0, 31744
    s_add_u32 s4, s4, 28672
    buffer_load_dwordx4 v17, s[8:11], s4 offen nt lds
    s_waitcnt vmcnt(12)
    ds_read_b64_tr_b16 v[96:97], v25 offset:16384
    ds_read_b64_tr_b16 v[98:99], v25 offset:16896
    ds_read_b64_tr_b16 v[100:101], v26 offset:16384
    ds_read_b64_tr_b16 v[102:103], v26 offset:16896
    ds_read_b64_tr_b16 v[104:105], v27 offset:16384
    ds_read_b64_tr_b16 v[106:107], v27 offset:16896
    ds_read_b64_tr_b16 v[108:109], v28 offset:16384
    ds_read_b64_tr_b16 v[110:111], v28 offset:16896
    s_waitcnt vmcnt(8)
    ds_read_b64_tr_b16 v[112:113], v25 offset:20480
    ds_read_b64_tr_b16 v[114:115], v25 offset:20992
    ds_read_b64_tr_b16 v[116:117], v26 offset:20480
    ds_read_b64_tr_b16 v[118:119], v26 offset:20992
    ds_read_b64_tr_b16 v[120:121], v27 offset:20480
    ds_read_b64_tr_b16 v[122:123], v27 offset:20992
    ds_read_b64_tr_b16 v[124:125], v28 offset:20480
    ds_read_b64_tr_b16 v[126:127], v28 offset:20992
    s_waitcnt lgkmcnt(8)
    v_mfma_f32_16x16x32_bf16 v[32:35], v[96:99], v[48:51], 0
    v_mfma_f32_16x16x32_bf16 v[36:39], v[100:103], v[48:51], 0
    v_mfma_f32_16x16x32_bf16 v[40:43], v[104:107], v[48:51], 0
    v_mfma_f32_16x16x32_bf16 v[44:47], v[108:111], v[48:51], 0
    s_waitcnt vmcnt(4)
    ds_read_b64_tr_b16 v[128:129], v25 offset:24576
    ds_read_b64_tr_b16 v[130:131], v25 offset:25088
    ds_read_b64_tr_b16 v[132:133], v26 offset:24576
    ds_read_b64_tr_b16 v[134:135], v26 offset:25088
    ds_read_b64_tr_b16 v[136:137], v27 offset:24576
    ds_read_b64_tr_b16 v[138:139], v27 offset:25088
    ds_read_b64_tr_b16 v[140:141], v28 offset:24576
    ds_read_b64_tr_b16 v[142:143], v28 offset:25088
    s_waitcnt lgkmcnt(8)
    v_mfma_f32_16x16x32_bf16 v[32:35], v[112:115], v[52:55], v[32:35]
    v_mfma_f32_16x16x32_bf16 v[36:39], v[116:119], v[52:55], v[36:39]
    v_mfma_f32_16x16x32_bf16 v[40:43], v[120:123], v[52:55], v[40:43]
    v_mfma_f32_16x16x32_bf16 v[44:47], v[124:127], v[52:55], v[44:47]
    s_waitcnt vmcnt(0)
    ds_read_b64_tr_b16 v[144:145], v25 offset:28672
    ds_read_b64_tr_b16 v[146:147], v25 offset:29184
    ds_read_b64_tr_b16 v[148:149], v26 offset:28672
    ds_read_b64_tr_b16 v[150:151], v26 offset:29184
    ds_read_b64_tr_b16 v[152:153], v27 offset:28672
    ds_read_b64_tr_b16 v[154:155], v27 offset:29184
    ds_read_b64_tr_b16 v[156:157], v28 offset:28672
    ds_read_b64_tr_b16 v[158:159], v28 offset:29184
    s_waitcnt lgkmcnt(8)
    v_mfma_f32_16x16x32_bf16 v[32:35], v[128:131], v[56:59], v[32:35]
    v_mfma_f32_16x16x32_bf16 v[36:39], v[132:135], v[56:59], v[36:39]
    v_mfma_f32_16x16x32_bf16 v[40:43], v[136:139], v[56:59], v[40:43]
    v_mfma_f32_16x16x32_bf16 v[44:47], v[140:143], v[56:59], v[44:47]
    s_waitcnt lgkmcnt(0)
    v_mfma_f32_16x16x32_bf16 v[32:35], v[144:147], v[60:63], v[32:35]
    v_mfma_f32_16x16x32_bf16 v[36:39], v[148:151], v[60:63], v[36:39]
    v_mfma_f32_16x16x32_bf16 v[40:43], v[152:155], v[60:63], v[40:43]
    v_mfma_f32_16x16x32_bf16 v[44:47], v[156:159], v[60:63], v[44:47]
    s_nop 5
    v_cndmask_b32 v32, v32, v36, s[34:35]
    v_cndmask_b32 v33, v33, v37, s[34:35]
    v_cndmask_b32 v34, v34, v38, s[34:35]
    v_cndmask_b32 v35, v35, v39, s[34:35]
    v_cndmask_b32 v32, v32, v40, s[36:37]
    v_cndmask_b32 v33, v33, v41, s[36:37]
    v_cndmask_b32 v34, v34, v42, s[36:37]
    v_cndmask_b32 v35, v35, v43, s[36:37]
    v_cndmask_b32 v32, v32, v44, s[42:43]
    v_cndmask_b32 v33, v33, v45, s[42:43]
    v_cndmask_b32 v34, v34, v46, s[42:43]
    v_cndmask_b32 v35, v35, v47, s[42:43]
    v_bfi_b32 v32, 15, v80, v32
    v_bfi_b32 v33, 15, v81, v33
    v_bfi_b32 v34, 15, v82, v34
    v_bfi_b32 v35, 15, v83, v35
    s_mov_b32 exec_lo, 0x000f000f
    s_mov_b32 exec_hi, 0x000f000f
    buffer_store_dwordx4 v[32:35], v22, s[20:23], s5 offen sc1
    s_mov_b64 exec, -1
    s_mov_b32 m0, 49152
    s_add_u32 s7, s61, 0
    buffer_load_dwordx4 v19, s[16:19], s7 offen nt lds
    s_mov_b32 m0, 50176
    s_add_u32 s7, s61, 8192
    buffer_load_dwordx4 v20, s[16:19], s7 offen nt lds
    s_mov_b32 m0, 51200
    s_add_u32 s7, s61, 16384
    buffer_load_dwordx4 v19, s[16:19], s7 offen nt lds
    s_mov_b32 m0, 52224
    s_add_u32 s7, s61, 24576
    buffer_load_dwordx4 v20, s[16:19], s7 offen nt lds
    s_mov_b32 m0, 53248
    s_add_u32 s7, s61, 32768
    buffer_load_dwordx4 v19, s[16:19], s7 offen nt lds
    s_mov_b32 m0, 54272
    s_add_u32 s7, s61, 40960
    buffer_load_dwordx4 v20, s[16:19], s7 offen nt lds
    s_mov_b32 m0, 55296
    s_add_u32 s7, s61, 49152
    buffer_load_dwordx4 v19, s[16:19], s7 offen nt lds
    s_mov_b32 m0, 56320
    s_add_u32 s7, s61, 57344
    buffer_load_dwordx4 v20, s[16:19], s7 offen nt lds
    s_mov_b32 m0, 57344
    s_add_u32 s7, s61, 65536
    buffer_load_dwordx4 v19, s[16:19], s7 offen nt lds
    s_mov_b32 m0, 58368
    s_add_u32 s7, s61, 73728
    buffer_load_dwordx4 v20, s[16:19], s7 offen nt lds
    s_mov_b32 m0, 59392
    s_add_u32 s7, s61, 81920
    buffer_load_dwordx4 v19, s[16:19], s7 offen nt lds
    s_mov_b32 m0, 60416
    s_add_u32 s7, s61, 90112
    buffer_load_dwordx4 v20, s[16:19], s7 offen nt lds
    s_mov_b32 m0, 61440
    s_add_u32 s7, s61, 98304
    buffer_load_dwordx4 v19, s[16:19], s7 offen nt lds
    s_mov_b32 m0, 62464
    s_add_u32 s7, s61, 106496
    buffer_load_dwordx4 v20, s[16:19], s7 offen nt lds
    s_mov_b32 m0, 63488
    s_add_u32 s7, s61, 114688
    buffer_load_dwordx4 v19, s[16:19], s7 offen nt lds
    s_mov_b32 m0, 64512
    s_add_u32 s7, s61, 122880
    buffer_load_dwordx4 v20, s[16:19], s7 offen nt lds
    s_cmp_lt_u32 s26, 18
    s_cbranch_scc1 L_nofc
    s_mov_b32 s4, 0xbdd2d3e8
    s_mov_b32 s5, s4
    s_mov_b32 s60, 0xc0135761
    s_mov_b32 s61, s60
    s_waitcnt vmcnt(12)
    ds_read_b64_tr_b16 v[160:161], v25 offset:49152
    ds_read_b64_tr_b16 v[162:163], v25 offset:49664
    ds_read_b64_tr_b16 v[164:165], v26 offset:49152
    ds_read_b64_tr_b16 v[166:167], v26 offset:49664
    ds_read_b64_tr_b16 v[168:169], v27 offset:49152
    ds_read_b64_tr_b16 v[170:171], v27 offset:49664
    ds_read_b64_tr_b16 v[172:173], v28 offset:49152
    ds_read_b64_tr_b16 v[174:175], v28 offset:49664
    s_waitcnt vmcnt(8)
    ds_read_b64_tr_b16 v[176:177], v25 offset:53248
    ds_read_b64_tr_b16 v[178:179], v25 offset:53760
    ds_read_b64_tr_b16 v[180:181], v26 offset:53248
    ds_read_b64_tr_b16 v[182:183], v26 offset:53760
    ds_read_b64_tr_b16 v[184:185], v27 offset:53248
    ds_read_b64_tr_b16 v[186:187], v27 offset:53760
    ds_read_b64_tr_b16 v[188:189], v28 offset:53248
    ds_read_b64_tr_b16 v[190:191], v28 offset:53760
    s_waitcnt vmcnt(4)
    ds_read_b64_tr_b16 v[192:193], v25 offset:57344
    ds_read_b64_tr_b16 v[194:195], v25 offset:57856
    ds_read_b64_tr_b16 v[196:197], v26 offset:57344
    ds_read_b64_tr_b16 v[198:199], v26 offset:57856
    ds_read_b64_tr_b16 v[200:201], v27 offset:57344
    ds_read_b64_tr_b16 v[202:203], v27 offset:57856
    ds_read_b64_tr_b16 v[204:205], v28 offset:57344
    ds_read_b64_tr_b16 v[206:207], v28 offset:57856
    s_waitcnt vmcnt(0)
    ds_read_b64_tr_b16 v[208:209], v25 offset:61440
    ds_read_b64_tr_b16 v[210:211], v25 offset:61952
    ds_read_b64_tr_b16 v[212:213], v26 offset:61440
    ds_read_b64_tr_b16 v[214:215], v26 offset:61952
    ds_read_b64_tr_b16 v[216:217], v27 offset:61440
    ds_read_b64_tr_b16 v[218:219], v27 offset:61952
    ds_read_b64_tr_b16 v[220:221], v28 offset:61440
    ds_read_b64_tr_b16 v[222:223], v28 offset:61952
    s_mov_b32 s31, 0x40000
L_pa:
    buffer_load_dwordx4 v[32:35], v3, s[20:23], s56 offen offset:0 sc1
    buffer_load_dwordx4 v[36:39], v3, s[20:23], s56 offen offset:1024 sc1
    buffer_load_dwordx4 v[40:43], v3, s[20:23], s56 offen offset:2048 sc1
    buffer_load_dwordx4 v[44:47], v3, s[20:23], s56 offen offset:3072 sc1
    s_waitcnt vmcnt(3)
    v_xor_b32 v32, v80, v32
    v_xor_b32 v33, v81, v33
    v_xor_b32 v34, v82, v34
    v_xor_b32 v35, v83, v35
    v_or_b32 v23, v32, v33
    v_or3_b32 v23, v34, v35, v23
    s_waitcnt vmcnt(2)
    v_xor_b32 v36, v80, v36
    v_xor_b32 v37, v81, v37
    v_xor_b32 v38, v82, v38
    v_xor_b32 v39, v83, v39
    v_or3_b32 v23, v36, v37, v23
    v_or3_b32 v23, v38, v39, v23
    v_pk_add_f32 v[32:33], v[32:33], v[36:37]
    v_pk_add_f32 v[34:35], v[34:35], v[38:39]
    s_waitcnt vmcnt(1)
    v_xor_b32 v40, v80, v40
    v_xor_b32 v41, v81, v41
    v_xor_b32 v42, v82, v42
    v_xor_b32 v43, v83, v43
    v_or3_b32 v23, v40, v41, v23
    v_or3_b32 v23, v42, v43, v23
    v_pk_add_f32 v[32:33], v[32:33], v[40:41]
    v_pk_add_f32 v[34:35], v[34:35], v[42:43]
    s_waitcnt vmcnt(0)
    v_xor_b32 v44, v80, v44
    v_xor_b32 v45, v81, v45
    v_xor_b32 v46, v82, v46
    v_xor_b32 v47, v83, v47
    v_or3_b32 v23, v44, v45, v23
    v_or3_b32 v23, v46, v47, v23
    v_pk_add_f32 v[32:33], v[32:33], v[44:45]
    v_pk_add_f32 v[34:35], v[34:35], v[46:47]
    v_and_b32 v23, 15, v23
    v_cmp_ne_u32 vcc, 0, v23
    s_cbranch_vccz L_pa_done
    s_sleep 2
    s_sub_u32 s31, s31, 1
    s_cbranch_scc0 L_pa
L_pa_done:
    v_permlane32_swap_b32 v32, v34
    v_permlane32_swap_b32 v33, v35
    v_mov_b32 v38, s60
    v_mov_b32 v39, s60
    v_cvt_pk_bf16_f32 v23, v32, v33
    v_lshlrev_b32 v32, 16, v23
    v_and_b32 v33, 0xffff0000, v23
    v_cvt_pk_bf16_f32 v23, v34, v35
    v_lshlrev_b32 v34, 16, v23
    v_and_b32 v35, 0xffff0000, v23
    v_pk_mul_f32 v[36:37], v[32:33], v[32:33]
    v_pk_fma_f32 v[36:37], v[36:37], s[4:5], v[38:39]
    v_pk_mul_f32 v[36:37], v[36:37], v[32:33]
    v_exp_f32 v36, v36
    v_exp_f32 v37, v37
    v_add_f32 v36, 1.0, v36
    v_add_f32 v37, 1.0, v37
    v_rcp_f32 v36, v36
    v_rcp_f32 v37, v37
    s_nop 0
    v_pk_mul_f32 v[36:37], v[36:37], v[32:33]
    v_cvt_pk_bf16_f32 v23, v36, v37
    v_lshlrev_b32 v36, 16, v23
    v_and_b32 v37, 0xffff0000, v23
    v_pk_mul_f32 v[36:37], v[36:37], v[34:35]
    v_cvt_pk_bf16_f32 v36, v36, v37
    ds_write_b32 v30, v36
    ds_read_b128 v[64:67], v24 offset:0
    ds_read_b128 v[68:71], v24 offset:64
    ds_read_b128 v[72:75], v24 offset:128
    ds_read_b128 v[76:79], v24 offset:192
    s_waitcnt lgkmcnt(3)
    v_mfma_f32_16x16x32_bf16 v[48:51], v[160:163], v[64:67], 0
    v_mfma_f32_16x16x32_bf16 v[52:55], v[164:167], v[64:67], 0
    v_mfma_f32_16x16x32_bf16 v[56:59], v[168:171], v[64:67], 0
    v_mfma_f32_16x16x32_bf16 v[60:63], v[172:175], v[64:67], 0
    s_waitcnt lgkmcnt(2)
    v_mfma_f32_16x16x32_bf16 v[48:51], v[176:179], v[68:71], v[48:51]
    v_mfma_f32_16x16x32_bf16 v[52:55], v[180:183], v[68:71], v[52:55]
    v_mfma_f32_16x16x32_bf16 v[56:59], v[184:187], v[68:71], v[56:59]
    v_mfma_f32_16x16x32_bf16 v[60:63], v[188:191], v[68:71], v[60:63]
    s_waitcnt lgkmcnt(1)
    v_mfma_f32_16x16x32_bf16 v[48:51], v[192:195], v[72:75], v[48:51]
    v_mfma_f32_16x16x32_bf16 v[52:55], v[196:199], v[72:75], v[52:55]
    v_mfma_f32_16x16x32_bf16 v[56:59], v[200:203], v[72:75], v[56:59]
    v_mfma_f32_16x16x32_bf16 v[60:63], v[204:207], v[72:75], v[60:63]
    s_waitcnt lgkmcnt(0)
    v_mfma_f32_16x16x32_bf16 v[48:51], v[208:211], v[76:79], v[48:51]
    v_mfma_f32_16x16x32_bf16 v[52:55], v[212:215], v[76:79], v[52:55]
    v_mfma_f32_16x16x32_bf16 v[56:59], v[216:219], v[76:79], v[56:59]
    v_mfma_f32_16x16x32_bf16 v[60:63], v[220:223], v[76:79], v[60:63]
    s_nop 5
    v_cndmask_b32 v48, v48, v52, s[34:35]
    v_cndmask_b32 v49, v49, v53, s[34:35]
    v_cndmask_b32 v50, v50, v54, s[34:35]
    v_cndmask_b32 v51, v51, v55, s[34:35]
    v_cndmask_b32 v48, v48, v56, s[36:37]
    v_cndmask_b32 v49, v49, v57, s[36:37]
    v_cndmask_b32 v50, v50, v58, s[36:37]
    v_cndmask_b32 v51, v51, v59, s[36:37]
    v_cndmask_b32 v48, v48, v60, s[42:43]
    v_cndmask_b32 v49, v49, v61, s[42:43]
    v_cndmask_b32 v50, v50, v62, s[42:43]
    v_cndmask_b32 v51, v51, v63, s[42:43]
    v_bfi_b32 v48, 15, v84, v48
    v_bfi_b32 v49, 15, v85, v49
    v_bfi_b32 v50, 15, v86, v50
    v_bfi_b32 v51, 15, v87, v51
    s_mov_b32 exec_lo, 0x000f000f
    s_mov_b32 exec_hi, 0x000f000f
    buffer_store_dwordx4 v[48:51], v29, s[20:23], s62 offen sc1
    s_mov_b64 exec, -1
    s_branch L_nofc
L_vb:
    s_cmp_lt_u32 s26, 4
    s_cbranch_scc1 L_nab
    s_mov_b32 s31, 0x80000
    ds_read_b32 v23, v21 offset:24
    s_waitcnt lgkmcnt(0)
    v_readfirstlane_b32 s3, v23
    s_cmp_ge_u32 s3, 2
    s_cbranch_scc1 L_tab_ok
L_tab:
    s_sleep 2
    ds_read_b32 v23, v21 offset:24
    s_sub_u32 s31, s31, 1
    s_cselect_b32 s7, 0x7fffffff, 0
    s_waitcnt lgkmcnt(0)
    v_readfirstlane_b32 s3, v23
    s_or_b32 s3, s3, s7
    s_cmp_ge_u32 s3, 2
    s_cbranch_scc0 L_tab
L_tab_ok:
    s_mov_b32 m0, 16384
    s_nop 0
    buffer_load_dwordx4 v16, s[8:11], s4 offen nt lds
    s_mov_b32 m0, 17408
    s_add_u32 s4, s4, 28672
    buffer_load_dwordx4 v17, s[8:11], s4 offen nt lds
    s_mov_b32 m0, 18432
    s_add_u32 s4, s4, 28672
    buffer_load_dwordx4 v16, s[8:11], s4 offen nt lds
    s_mov_b32 m0, 19456
    s_add_u32 s4, s4, 28672
    buffer_load_dwordx4 v17, s[8:11], s4 offen nt lds
    s_mov_b32 m0, 20480
    s_add_u32 s4, s4, 28672
    buffer_load_dwordx4 v16, s[8:11], s4 offen nt lds
    s_mov_b32 m0, 21504
    s_add_u32 s4, s4, 28672
    buffer_load_dwordx4 v17, s[8:11], s4 offen nt lds
    s_mov_b32 m0, 22528
    s_add_u32 s4, s4, 28672
    buffer_load_dwordx4 v16, s[8:11], s4 offen nt lds
    s_mov_b32 m0, 23552
    s_add_u32 s4, s4, 28672
    buffer_load_dwordx4 v17, s[8:11], s4 offen nt lds
    s_mov_b32 m0, 24576
    s_add_u32 s4, s4, 28672
    buffer_load_dwordx4 v16, s[8:11], s4 offen nt lds
    s_mov_b32 m0, 25600
    s_add_u32 s4, s4, 28672
    buffer_load_dwordx4 v17, s[8:11], s4 offen nt lds
    s_mov_b32 m0, 26624
    s_add_u32 s4, s4, 28672
    buffer_load_dwordx4 v16, s[8:11], s4 offen nt lds
    s_mov_b32 m0, 27648
    s_add_u32 s4, s4, 28672
    buffer_load_dwordx4 v17, s[8:11], s4 offen nt lds
    s_mov_b32 m0, 28672
    s_add_u32 s4, s4, 28672
    buffer_load_dwordx4 v16, s[8:11], s4 offen nt lds
    s_mov_b32 m0, 29696
    s_add_u32 s4, s4, 28672
    buffer_load_dwordx4 v17, s[8:11], s4 offen nt lds
    s_mov_b32 m0, 30720
    s_add_u32 s4, s4, 28672
    buffer_load_dwordx4 v16, s[8:11], s4 offen nt lds
    s_mov_b32 m0, 31744
    s_add_u32 s4, s4, 28672
    buffer_load_dwordx4 v17, s[8:11], s4 offen nt lds
L_nab:
    s_mov_b32 s31, 0x80000
    ds_read_b32 v23, v21 offset:24
    s_waitcnt lgkmcnt(0)
    v_readfirstlane_b32 s3, v23
    s_cmp_ge_u32 s3, 4
    s_cbranch_scc1 L_twb_ok
L_twb:
    s_sleep 2
    ds_read_b32 v23, v21 offset:24
    s_sub_u32 s31, s31, 1
    s_cselect_b32 s7, 0x7fffffff, 0
    s_waitcnt lgkmcnt(0)
    v_readfirstlane_b32 s3, v23
    s_or_b32 s3, s3, s7
    s_cmp_ge_u32 s3, 4
    s_cbranch_scc0 L_twb
L_twb_ok:
    s_mov_b32 m0, 81920
    s_add_u32 s7, s63, 0
    buffer_load_dwordx4 v19, s[12:15], s7 offen nt lds
    s_mov_b32 m0, 82944
    s_add_u32 s7, s63, 8192
    buffer_load_dwordx4 v20, s[12:15], s7 offen nt lds
    s_mov_b32 m0, 83968
    s_add_u32 s7, s63, 16384
    buffer_load_dwordx4 v19, s[12:15], s7 offen nt lds
    s_mov_b32 m0, 84992
    s_add_u32 s7, s63, 24576
    buffer_load_dwordx4 v20, s[12:15], s7 offen nt lds
    s_mov_b32 m0, 86016
    s_add_u32 s7, s63, 32768
    buffer_load_dwordx4 v19, s[12:15], s7 offen nt lds
    s_mov_b32 m0, 87040
    s_add_u32 s7, s63, 40960
    buffer_load_dwordx4 v20, s[12:15], s7 offen nt lds
    s_mov_b32 m0, 88064
    s_add_u32 s7, s63, 49152
    buffer_load_dwordx4 v19, s[12:15], s7 offen nt lds
    s_mov_b32 m0, 89088
    s_add_u32 s7, s63, 57344
    buffer_load_dwordx4 v20, s[12:15], s7 offen nt lds
    s_mov_b32 m0, 90112
    s_add_u32 s7, s63, 128
    buffer_load_dwordx4 v19, s[12:15], s7 offen nt lds
    s_mov_b32 m0, 91136
    s_add_u32 s7, s63, 8320
    buffer_load_dwordx4 v20, s[12:15], s7 offen nt lds
    s_mov_b32 m0, 92160
    s_add_u32 s7, s63, 16512
    buffer_load_dwordx4 v19, s[12:15], s7 offen nt lds
    s_mov_b32 m0, 93184
    s_add_u32 s7, s63, 24704
    buffer_load_dwordx4 v20, s[12:15], s7 offen nt lds
    s_mov_b32 m0, 94208
    s_add_u32 s7, s63, 32896
    buffer_load_dwordx4 v19, s[12:15], s7 offen nt lds
    s_mov_b32 m0, 95232
    s_add_u32 s7, s63, 41088
    buffer_load_dwordx4 v20, s[12:15], s7 offen nt lds
    s_mov_b32 m0, 96256
    s_add_u32 s7, s63, 49280
    buffer_load_dwordx4 v19, s[12:15], s7 offen nt lds
    s_mov_b32 m0, 97280
    s_add_u32 s7, s63, 57472
    buffer_load_dwordx4 v20, s[12:15], s7 offen nt lds
    s_mov_b32 m0, 114688
    s_add_u32 s7, s63, 256
    buffer_load_dwordx4 v19, s[12:15], s7 offen nt lds
    s_mov_b32 m0, 115712
    s_add_u32 s7, s63, 8448
    buffer_load_dwordx4 v20, s[12:15], s7 offen nt lds
    s_mov_b32 m0, 116736
    s_add_u32 s7, s63, 16640
    buffer_load_dwordx4 v19, s[12:15], s7 offen nt lds
    s_mov_b32 m0, 117760
    s_add_u32 s7, s63, 24832
    buffer_load_dwordx4 v20, s[12:15], s7 offen nt lds
    s_mov_b32 m0, 118784
    s_add_u32 s7, s63, 33024
    buffer_load_dwordx4 v19, s[12:15], s7 offen nt lds
    s_mov_b32 m0, 119808
    s_add_u32 s7, s63, 41216
    buffer_load_dwordx4 v20, s[12:15], s7 offen nt lds
    s_mov_b32 m0, 120832
    s_add_u32 s7, s63, 49408
    buffer_load_dwordx4 v19, s[12:15], s7 offen nt lds
    s_mov_b32 m0, 121856
    s_add_u32 s7, s63, 57600
    buffer_load_dwordx4 v20, s[12:15], s7 offen nt lds
    s_mov_b32 m0, 122880
    s_add_u32 s7, s63, 384
    buffer_load_dwordx4 v19, s[12:15], s7 offen nt lds
    s_mov_b32 m0, 123904
    s_add_u32 s7, s63, 8576
    buffer_load_dwordx4 v20, s[12:15], s7 offen nt lds
    s_mov_b32 m0, 124928
    s_add_u32 s7, s63, 16768
    buffer_load_dwordx4 v19, s[12:15], s7 offen nt lds
    s_mov_b32 m0, 125952
    s_add_u32 s7, s63, 24960
    buffer_load_dwordx4 v20, s[12:15], s7 offen nt lds
    s_mov_b32 m0, 126976
    s_add_u32 s7, s63, 33152
    buffer_load_dwordx4 v19, s[12:15], s7 offen nt lds
    s_mov_b32 m0, 128000
    s_add_u32 s7, s63, 41344
    buffer_load_dwordx4 v20, s[12:15], s7 offen nt lds
    s_mov_b32 m0, 129024
    s_add_u32 s7, s63, 49536
    buffer_load_dwordx4 v19, s[12:15], s7 offen nt lds
    s_mov_b32 m0, 130048
    s_add_u32 s7, s63, 57728
    buffer_load_dwordx4 v20, s[12:15], s7 offen nt lds
    s_cmp_lt_u32 s26, 4
    s_cbranch_scc1 L_nbb
    s_waitcnt vmcnt(44)
    ds_read_b64_tr_b16 v[96:97], v25 offset:16384
    ds_read_b64_tr_b16 v[98:99], v25 offset:16896
    ds_read_b64_tr_b16 v[100:101], v26 offset:16384
    ds_read_b64_tr_b16 v[102:103], v26 offset:16896
    ds_read_b64_tr_b16 v[104:105], v27 offset:16384
    ds_read_b64_tr_b16 v[106:107], v27 offset:16896
    ds_read_b64_tr_b16 v[108:109], v28 offset:16384
    ds_read_b64_tr_b16 v[110:111], v28 offset:16896
    s_waitcnt vmcnt(40)
    ds_read_b64_tr_b16 v[112:113], v25 offset:20480
    ds_read_b64_tr_b16 v[114:115], v25 offset:20992
    ds_read_b64_tr_b16 v[116:117], v26 offset:20480
    ds_read_b64_tr_b16 v[118:119], v26 offset:20992
    ds_read_b64_tr_b16 v[120:121], v27 offset:20480
    ds_read_b64_tr_b16 v[122:123], v27 offset:20992
    ds_read_b64_tr_b16 v[124:125], v28 offset:20480
    ds_read_b64_tr_b16 v[126:127], v28 offset:20992
    s_waitcnt lgkmcnt(8)
    v_mfma_f32_16x16x32_bf16 v[32:35], v[96:99], v[48:51], 0
    v_mfma_f32_16x16x32_bf16 v[36:39], v[100:103], v[48:51], 0
    v_mfma_f32_16x16x32_bf16 v[40:43], v[104:107], v[48:51], 0
    v_mfma_f32_16x16x32_bf16 v[44:47], v[108:111], v[48:51], 0
    s_waitcnt vmcnt(36)
    ds_read_b64_tr_b16 v[128:129], v25 offset:24576
    ds_read_b64_tr_b16 v[130:131], v25 offset:25088
    ds_read_b64_tr_b16 v[132:133], v26 offset:24576
    ds_read_b64_tr_b16 v[134:135], v26 offset:25088
    ds_read_b64_tr_b16 v[136:137], v27 offset:24576
    ds_read_b64_tr_b16 v[138:139], v27 offset:25088
    ds_read_b64_tr_b16 v[140:141], v28 offset:24576
    ds_read_b64_tr_b16 v[142:143], v28 offset:25088
    s_waitcnt lgkmcnt(8)
    v_mfma_f32_16x16x32_bf16 v[32:35], v[112:115], v[52:55], v[32:35]
    v_mfma_f32_16x16x32_bf16 v[36:39], v[116:119], v[52:55], v[36:39]
    v_mfma_f32_16x16x32_bf16 v[40:43], v[120:123], v[52:55], v[40:43]
    v_mfma_f32_16x16x32_bf16 v[44:47], v[124:127], v[52:55], v[44:47]
    s_waitcnt vmcnt(32)
    ds_read_b64_tr_b16 v[144:145], v25 offset:28672
    ds_read_b64_tr_b16 v[146:147], v25 offset:29184
    ds_read_b64_tr_b16 v[148:149], v26 offset:28672
    ds_read_b64_tr_b16 v[150:151], v26 offset:29184
    ds_read_b64_tr_b16 v[152:153], v27 offset:28672
    ds_read_b64_tr_b16 v[154:155], v27 offset:29184
    ds_read_b64_tr_b16 v[156:157], v28 offset:28672
    ds_read_b64_tr_b16 v[158:159], v28 offset:29184
    s_waitcnt lgkmcnt(8)
    v_mfma_f32_16x16x32_bf16 v[32:35], v[128:131], v[56:59], v[32:35]
    v_mfma_f32_16x16x32_bf16 v[36:39], v[132:135], v[56:59], v[36:39]
    v_mfma_f32_16x16x32_bf16 v[40:43], v[136:139], v[56:59], v[40:43]
    v_mfma_f32_16x16x32_bf16 v[44:47], v[140:143], v[56:59], v[44:47]
    s_waitcnt lgkmcnt(0)
    v_mfma_f32_16x16x32_bf16 v[32:35], v[144:147], v[60:63], v[32:35]
    v_mfma_f32_16x16x32_bf16 v[36:39], v[148:151], v[60:63], v[36:39]
    v_mfma_f32_16x16x32_bf16 v[40:43], v[152:155], v[60:63], v[40:43]
    v_mfma_f32_16x16x32_bf16 v[44:47], v[156:159], v[60:63], v[44:47]
    s_nop 5
    v_cndmask_b32 v32, v32, v36, s[34:35]
    v_cndmask_b32 v33, v33, v37, s[34:35]
    v_cndmask_b32 v34, v34, v38, s[34:35]
    v_cndmask_b32 v35, v35, v39, s[34:35]
    v_cndmask_b32 v32, v32, v40, s[36:37]
    v_cndmask_b32 v33, v33, v41, s[36:37]
    v_cndmask_b32 v34, v34, v42, s[36:37]
    v_cndmask_b32 v35, v35, v43, s[36:37]
    v_cndmask_b32 v32, v32, v44, s[42:43]
    v_cndmask_b32 v33, v33, v45, s[42:43]
    v_cndmask_b32 v34, v34, v46, s[42:43]
    v_cndmask_b32 v35, v35, v47, s[42:43]
    v_bfi_b32 v32, 15, v80, v32
    v_bfi_b32 v33, 15, v81, v33
    v_bfi_b32 v34, 15, v82, v34
    v_bfi_b32 v35, 15, v83, v35
    s_mov_b32 exec_lo, 0x000f000f
    s_mov_b32 exec_hi, 0x000f000f
    buffer_store_dwordx4 v[32:35], v22, s[20:23], s5 offen sc1
    s_mov_b64 exec, -1
L_nbb:
    v_mov_b32 v23, 1
    s_waitcnt vmcnt(1)
    s_cmp_ge_u32 s26, 4
    s_cbranch_scc1 L_ncb
    s_waitcnt vmcnt(0)
L_ncb:
    ds_write_b32 v21, v23 offset:36
L_nofp:
    s_cmp_ge_u32 s93, 64
    s_cbranch_scc1 L_nofc
    v_lshlrev_b32 v56, 16, v18
    v_and_b32 v57, 0xffff0000, v18
    v_lshlrev_b32 v21, 3, v0
    v_add_u32 v21, 150016, v21
    s_mov_b64 exec, 0xffff
    ds_write_b64 v21, v[56:57]
    s_mov_b64 exec, -1
    v_and_b32 v22, 1, v0
    v_lshlrev_b32 v22, 6, v22
    v_lshl_or_b32 v22, v1, 2, v22
    v_bfe_u32 v21, v0, 1, 2
    v_lshl_or_b32 v22, v21, 4, v22
    v_add_u32 v22, 149888, v22
    v_mov_b32 v21, 150144
    s_mov_b32 s31, 0x80000
    ds_read_b32 v23, v21 offset:16
    s_waitcnt lgkmcnt(0)
    v_readfirstlane_b32 s3, v23
    s_cmp_ge_u32 s3, 3
    s_cbranch_scc1 L_fw_ok
L_fw:
    s_sleep 2
    ds_read_b32 v23, v21 offset:16
    s_sub_u32 s31, s31, 1
    s_cselect_b32 s7, 0x7fffffff, 0
    s_waitcnt lgkmcnt(0)
    v_readfirstlane_b32 s3, v23
    s_or_b32 s3, s3, s7
    s_cmp_ge_u32 s3, 3
    s_cbranch_scc0 L_fw
L_fw_ok:
    s_mul_i32 s4, s93, 2176
    s_add_u32 s4, s4, 3670016
    s_mov_b32 s7, 0xbfb8aa3b
    s_mov_b32 s31, 0x40000
L_pb:
    buffer_load_dwordx4 v[56:59], v3, s[20:23], s4 offen offset:0 sc1
    s_mov_b32 exec_hi, 0xffff
    buffer_load_dwordx4 v[60:63], v3, s[20:23], s4 offen offset:1024 sc1
    s_mov_b32 exec_hi, -1
    s_waitcnt vmcnt(1)
    v_xor_b32 v56, v80, v56
    v_xor_b32 v57, v81, v57
    v_xor_b32 v58, v82, v58
    v_xor_b32 v59, v83, v59
    v_or_b32 v23, v56, v57
    v_or3_b32 v23, v58, v59, v23
    s_waitcnt vmcnt(0)
    s_mov_b32 exec_hi, 0xffff
    v_xor_b32 v60, v80, v60
    v_xor_b32 v61, v81, v61
    v_xor_b32 v62, v82, v62
    v_xor_b32 v63, v83, v63
    v_or3_b32 v23, v60, v61, v23
    v_or3_b32 v23, v62, v63, v23
    v_pk_add_f32 v[56:57], v[56:57], v[60:61]
    v_pk_add_f32 v[58:59], v[58:59], v[62:63]
    s_mov_b32 exec_hi, -1
    v_and_b32 v23, 15, v23
    v_cmp_ne_u32 vcc, 0, v23
    s_cbranch_vccz L_pb_done
    s_sub_u32 s31, s31, 1
    s_cbranch_scc0 L_pb
L_pb_done:
    s_nop 1
    v_permlane32_swap_b32 v56, v58
    v_permlane32_swap_b32 v57, v59
    v_add_f32 v56, v56, v58
    v_add_f32 v57, v57, v59
    s_nop 1
    v_permlane16_swap_b32 v56, v57
    v_add_f32 v56, v56, v57
    s_nop 1
    v_add_f32_dpp v56, v56, v56 row_ror:8 row_mask:0xf bank_mask:0xf
    v_cvt_pk_bf16_f32 v23, v56, v56
    v_lshlrev_b32 v56, 16, v23
    v_mul_f32 v57, s7, v56
    v_exp_f32 v57, v57
    v_mov_b32 v58, 1
    v_add_f32 v57, 1.0, v57
    v_rcp_f32 v57, v57
    v_mov_b32 v59, s30
    v_mul_f32 v56, v56, v57
    v_cvt_pk_bf16_f32 v23, v56, v56
    v_lshlrev_b32 v56, 16, v23
    ds_write_b32 v22, v56
    ds_write_b32 v21, v58 offset:28
    s_cmp_lg_u32 s2, 0
    s_cbranch_scc1 L_nofc
    s_mov_b64 exec, 1
    buffer_store_dword v59, off, s[20:23], 0 offset:0 sc1
    s_mov_b64 exec, -1
L_nofc:
    s_waitcnt vmcnt(0) lgkmcnt(0)
L_end:
    s_endpgm
.section .rodata,"a"
.p2align 6
.amdhsa_kernel recurrent_scan__gqa_block_cached__geglu_ffn__decode_kernel
  .amdhsa_next_free_vgpr 224
  .amdhsa_next_free_sgpr 100
  .amdhsa_accum_offset 224
  .amdhsa_group_segment_fixed_size 0
  .amdhsa_kernarg_size 96
  .amdhsa_user_sgpr_count 2
  .amdhsa_user_sgpr_kernarg_segment_ptr 1
  .amdhsa_system_sgpr_workgroup_id_x 1
.end_amdhsa_kernel
```
